```python
import torch

def _softmax(x, axis=-1):
    return torch.softmax(x, dim=axis)
def _gelu(x):
    return torch.nn.functional.gelu(x, approximate="tanh")
def _silu(x):
    return torch.nn.functional.silu(x)
def _sigmoid(x):
    return torch.sigmoid(x)
def _layernorm(x, axis=-1, eps=1e-5):
    m = x.mean(dim=axis, keepdim=True)
    v = x.var(dim=axis, keepdim=True, unbiased=False)
    return (x - m) / torch.sqrt(v + eps)
def _scatter_add(tgt, idx, src, axis=0):
    return tgt.clone().index_add_(axis, idx, src)
def _segment_sum(src, seg, n):
    out = torch.zeros((n,) + src.shape[1:], dtype=src.dtype)
    return out.index_add_(0, seg, src)
def _pad(x, pw):
    flat = tuple(v for pair in reversed(pw) for v in pair)
    return torch.nn.functional.pad(x, flat)

kernel_name = 'gated_mix__ssm_conv_h3__mixer_s_mlp__prompt'

def setup_inputs():

    _w = (lambda a: (lambda t: t.to(torch.bfloat16) if t.is_floating_point() else t)(torch.as_tensor(a)))
    def _A_setup():
        B, S, D = 1, 2048, 512
        ks = 4
        return {
            "q": _w((lambda *s: torch.randn(*s, dtype=torch.bfloat16) * 0.05)(B, S, D)),
            "k": _w((lambda *s: torch.randn(*s, dtype=torch.bfloat16) * 1.6)(B, S, D)),
            "v": _w((lambda *s: torch.randn(*s, dtype=torch.bfloat16) * 1.6)(B, S, D)),
            "shift_k": _w((lambda *s: torch.randn(*s, dtype=torch.bfloat16) * 1.6)(D, ks) * 0.5),
            "ssm_k": _w((lambda *s: torch.randn(*s, dtype=torch.bfloat16) * 3.2)(D, S) * (1.0 / S ** 0.5)),
            "ssm_D": _w((lambda *s: torch.randn(*s, dtype=torch.bfloat16) * 1.6)(D)),
        }
    _A_in = _A_setup()

    def _B_setup():
        B, S, D, F = 1, 2048, 512, 1792
        return {
            "x":  _w((lambda *s: torch.randn(*s, dtype=torch.bfloat16) * 0.05)(B, S, D)),
            "w1": _w((lambda *s: torch.randn(*s, dtype=torch.bfloat16) * 3.2)(D, D) * (D ** -0.5)),
            "w2": _w((lambda *s: torch.randn(*s, dtype=torch.bfloat16) * 3.2)(D, D) * (D ** -0.5)),
            "w3": _w((lambda *s: torch.randn(*s, dtype=torch.bfloat16) * 3.2)(D, F) * (D ** -0.5)),
            "w4": _w((lambda *s: torch.randn(*s, dtype=torch.bfloat16) * 1.6)(F, D) * (F ** -0.5)),
        }
    _B_in = _B_setup()

    return {
        "A_q": _A_in["q"],
        "A_k": _A_in["k"],
        "A_v": _A_in["v"],
        "A_shift_k": _A_in["shift_k"],
        "A_ssm_k": _A_in["ssm_k"],
        "A_ssm_D": _A_in["ssm_D"],
        "B_x": _B_in["x"],
        "B_w1": _B_in["w1"],
        "B_w2": _B_in["w2"],
        "B_w3": _B_in["w3"],
        "B_w4": _B_in["w4"],
        "gate_w": _w((lambda *s: torch.randn(*s, dtype=torch.bfloat16) * 0.05)(512) * 16.0),
    }

def reference(A_q, A_k, A_v, A_shift_k, A_ssm_k, A_ssm_D, B_x, B_w1, B_w2, B_w3, B_w4, gate_w):
    def _A_ref(q, k, v, shift_k, ssm_k, ssm_D):
        B, S, D = q.shape
        ks = shift_k.shape[-1]
        k_pad = _pad(k, ((0, 0), (ks - 1, 0), (0, 0)))
        k_shift = torch.zeros_like(k)
        for t in range(ks):
            k_shift = k_shift + k_pad[:, t:t + S, :] * shift_k[:, ks - 1 - t][None, None, :]
        kv = k_shift * v
        L = 2 * S
        kv_pad = _pad(kv, ((0, 0), (0, S), (0, 0)))
        kf_pad = _pad(ssm_k, ((0, 0), (0, S)))
        kv_f = (lambda x, axes=(-2,-1): torch.fft.rfft2(x.float(), dim=axes))(kv_pad[:, None, :, :], axes=(1, 2))
        kf_f = (lambda x, axes=(-2,-1): torch.fft.rfft2(x.float(), dim=axes))(kf_pad[:, None, :], axes=(1, 2))
        kf_f = (lambda x, *d: x.permute(*d))(kf_f, 1, 2, 0)
        y_f = kv_f * kf_f[None, :, :, :]
        y = (lambda x, s, axes=(-2,-1): torch.fft.irfft2(x, s=s, dim=axes).to(torch.bfloat16))(y_f, (1, L), axes=(1, 2))[:, 0, :S, :]
        y = y + kv * ssm_D[None, None, :]
        return q * y

    def _B_ref(x, w1, w2, w3, w4):
        B, S, D = x.shape
        h = _gelu(_layernorm(x, axis=-1) @ w1)
        c = D // 4
        g0 = _pad(h[:, :, 0*c:1*c], ((0, 0), (1, 0), (0, 0)))[:, :S, :]
        g1 = _pad(h[:, :, 1*c:2*c], ((0, 0), (0, 1), (0, 0)))[:, 1:, :]
        g2 = _pad(h[:, :, 2*c:3*c], ((0, 0), (2, 0), (0, 0)))[:, :S, :]
        g3 = _pad(h[:, :, 3*c:   ], ((0, 0), (0, 2), (0, 0)))[:, 2:, :]
        hs = torch.concatenate([g0, g1, g2, g3], axis=-1) @ w2
        x1 = x + hs
        h2 = _gelu(_layernorm(x1, axis=-1) @ w3) @ w4
        return x1 + h2

    x = A_q
    g = _sigmoid((x * gate_w).sum(-1, keepdims=True))
    a = _A_ref(x, A_k, A_v, A_shift_k, A_ssm_k, A_ssm_D)
    b = _B_ref(x, B_w1, B_w2, B_w3, B_w4)
    return g * a + (1 - g) * b
```

```asm
; @launch grid=(256,1,1) block=(256,1,1) lds=163840
.amdgcn_target "amdgcn-amd-amdhsa--gfx950"
.text
.globl gated_mix__ssm_conv_h3__mixer_s_mlp__prompt_kernel
.p2align 8
.type gated_mix__ssm_conv_h3__mixer_s_mlp__prompt_kernel,@function
gated_mix__ssm_conv_h3__mixer_s_mlp__prompt_kernel:
.set CODE_BYTES, L_code_end - L_pc - 4
    s_cmp_ge_u32 s2, 256
    s_cbranch_scc1 L_end
    s_load_dwordx16 s[64:79], s[0:1], 0
    s_getpc_b64 s[48:49]
L_pc:
    s_lshr_b32 s50, s2, 3
    s_lshl_b32 s50, s50, 10
    v_lshlrev_b32 v1, 7, v0
    v_add_u32 v2, s50, v1
    v_cmp_gt_u32 vcc, 32, v0
    s_nop 1
    v_cndmask_b32 v1, v2, v1, vcc
    v_min_u32 v1, CODE_BYTES, v1
    v_cmp_gt_u32 vcc, 40, v0
    s_and_saveexec_b64 s[50:51], vcc
    s_cbranch_execz L_nopf
    global_load_dword a255, v1, s[48:49]
L_nopf:
    s_mov_b64 exec, s[50:51]
    v_lshrrev_b32 v24, 6, v0
    v_and_b32 v1, 63, v0
    v_readfirstlane_b32 s54, v24
    v_lshrrev_b32 v21, 3, v1
    v_and_b32 v23, 7, v1
    s_and_b32 s52, s2, 7
    s_lshr_b32 s53, s2, 6
    s_lshl_b32 s58, s52, 2
    s_add_u32 s58, s58, s53
    s_bfe_u32 s59, s2, 0x30003
    s_add_u32 s62, s59, s53
    s_and_b32 s62, s62, 3
    s_and_b32 s55, s54, 1
    s_lshr_b32 s56, s54, 1
    s_lshl_b32 s80, s54, 14
    s_lshr_b32 s52, s59, 2
    s_add_u32 s52, s52, 1
    s_sub_u32 s53, 0, s52
    s_bitcmp1_b32 s59, 1
    s_cselect_b32 s52, s52, s53
    s_lshl_b32 s53, s58, 6
    s_add_u32 s52, s52, s53
    s_lshl_b32 s53, s55, 5
    s_add_u32 s52, s52, s53
    s_lshl_b32 s52, s52, 10
    s_lshl_b32 s53, s56, 9
    s_add_u32 s52, s52, s53
    v_lshrrev_b32 v22, 1, v21
    v_xor_b32 v22, v22, v23
    v_lshlrev_b32 v22, 4, v22
    v_lshl_add_u32 v22, v21, 10, v22
    v_add_u32 v9, s52, v22
    v_xor_b32 v22, 64, v22
    v_add_u32 v22, s52, v22
    v_add_u32 v10, 7168, v22
    v_add_u32 v11, 16384, v9
    v_add_u32 v12, 23552, v22
    s_mov_b32 s6, 2097152
    s_mov_b32 s7, 0x20000
    s_mov_b32 s22, 524288
    s_mov_b32 s23, 0x20000
    s_lshl_b32 s82, s56, 15
    s_lshl_b32 s53, s55, 12
    s_add_u32 s82, s82, s53
    s_lshl_b32 s81, s56, 18
    s_lshl_b32 s53, s55, 15
    s_add_u32 s81, s81, s53
    s_lshl_b32 s53, s59, 7
    s_add_u32 s81, s81, s53
    v_lshrrev_b32 v25, 2, v1
    v_and_b32 v25, 4, v25
    v_xor_b32 v25, v25, v23
    v_lshlrev_b32 v25, 4, v25
    v_lshl_add_u32 v7, v21, 10, v25
    v_add_u32 v6, 7168, v7
    s_add_u32 s46, s62, 0
    s_and_b32 s46, s46, 3
    s_lshl_b32 s46, s46, 7
    s_add_u32 s47, s62, 1
    s_and_b32 s47, s47, 3
    s_lshl_b32 s47, s47, 7
    s_add_u32 s3, s62, 2
    s_and_b32 s3, s3, 3
    s_lshl_b32 s3, s3, 7
    s_add_u32 s95, s62, 3
    s_and_b32 s95, s95, 3
    s_lshl_b32 s95, s95, 7
    s_waitcnt lgkmcnt(0)
    s_mov_b64 s[4:5], s[64:65]
    s_mov_b64 s[20:21], s[78:79]
    s_nop 0
    s_add_u32 m0, s80, 65536
    s_nop 0
    buffer_load_dwordx4 v9, s[4:7], s46 offen  lds
    buffer_load_dwordx4 v10, s[4:7], s46 offen offset:1024  lds
    s_add_u32 m0, s80, 67584
    s_nop 0
    buffer_load_dwordx4 v11, s[4:7], s46 offen  lds
    buffer_load_dwordx4 v12, s[4:7], s46 offen offset:1024  lds
    s_add_u32 m0, s82, 0
    s_lshl_b32 s84, s46, 9
    s_add_u32 s84, s84, s81
    buffer_load_dwordx4 v7, s[20:23], s84 offen  lds
    buffer_load_dwordx4 v6, s[20:23], s84 offen offset:1024  lds
    s_add_u32 m0, s82, 2048
    s_lshl_b32 s84, s46, 9
    s_add_u32 s84, s84, s81
    s_add_u32 s84, s84, 16384
    buffer_load_dwordx4 v7, s[20:23], s84 offen  lds
    buffer_load_dwordx4 v6, s[20:23], s84 offen offset:1024  lds
    s_load_dwordx2 s[40:41], s[0:1], 112
    s_load_dwordx2 s[24:25], s[0:1], 64
    s_load_dwordx2 s[28:29], s[0:1], 72
    s_load_dwordx2 s[32:33], s[0:1], 80
    s_load_dwordx2 s[52:53], s[0:1], 88
    s_load_dwordx2 s[36:37], s[0:1], 96
    s_waitcnt lgkmcnt(0)
    s_mov_b64 s[8:9], s[66:67]
    s_mov_b64 s[12:13], s[68:69]
    s_mov_b64 s[48:49], s[70:71]
    s_mov_b64 s[16:17], s[72:73]
    s_mov_b64 s[50:51], s[74:75]
    s_mov_b32 s10, 2097152
    s_mov_b32 s11, 0x20000
    s_mov_b32 s14, 2097152
    s_mov_b32 s15, 0x20000
    s_mov_b32 s18, 2097152
    s_mov_b32 s19, 0x20000
    s_mov_b32 s26, 524288
    s_mov_b32 s27, 0x20000
    s_mov_b32 s30, 1835008
    s_mov_b32 s31, 0x20000
    s_mov_b32 s34, 1835008
    s_mov_b32 s35, 0x20000
    s_mov_b32 s38, 2097152
    s_mov_b32 s39, 0x20000
    s_mov_b32 s42, 18874368
    s_mov_b32 s43, 0x20000
    v_lshlrev_b32 v2, 4, v1
    v_mov_b32 v19, 0
    s_xor_b32 s57, s55, s56
    s_mov_b32 s44, 0x00003f80
    s_mov_b32 s45, 0x3f800000
    s_add_u32 s94, s59, 1
    s_and_b32 s94, s94, 7
    s_add_u32 s63, s59, 2
    s_and_b32 s63, s63, 7
    s_mov_b32 s65, 0x3f803f80
    s_mov_b32 s66, 0xffff0000
    s_lshl_b32 s79, s58, 3
    s_add_u32 s79, s79, s59
    s_lshl_b32 s79, s79, 2
    s_add_u32 s79, s79, s54
    s_lshl_b32 s79, s79, 7
    s_lshr_b32 s67, s58, 3
    s_lshl_b32 s61, s67, 2
    s_and_b32 s67, s58, 3
    s_add_u32 s61, s61, s67
    s_bfe_u32 s67, s58, 0x10002
    s_mul_i32 s60, s67, 7
    s_add_u32 s60, s60, s59
    s_cmp_gt_u32 s59, 2
    s_cselect_b32 s67, 1, 0
    s_sub_u32 s60, s60, s67
    s_cmp_eq_u32 s59, 2
    s_cselect_b32 s88, 18874368, 0
    v_lshlrev_b32 v243, 7, v1
    v_mul_u32_u24 v8, 3584, v21
    v_add_u32 v8, v8, v25
    v_add_u32 v0, 27648, v8
    s_mul_i32 s83, s54, 458752
    s_lshl_b32 s68, s60, 8
    s_add_u32 s83, s83, s68
    s_add_u32 s83, s83, s88
    s_lshl_b32 s68, s63, 7
    s_lshl_b32 s67, s58, 16
    s_add_u32 s67, s67, s68
    v_lshlrev_b32 v250, 4, v23
    v_lshl_add_u32 v250, v21, 10, v250
    v_add_u32 v250, s67, v250
    v_subrev_u32 v251, 8192, v250
    s_load_dword s64, s[40:41], 262144
    v_lshrrev_b32 v21, 5, v1
    v_lshlrev_b32 v5, 10, v21
    v_lshlrev_b32 v20, 4, v21
    v_bfe_u32 v21, v1, 2, 2
    v_lshl_add_u32 v5, v21, 7, v5
    v_lshrrev_b32 v21, 1, v21
    v_lshl_add_u32 v5, v21, 6, v5
    v_bfe_u32 v21, v1, 4, 1
    v_lshl_add_u32 v5, v21, 5, v5
    v_and_b32 v21, 1, v1
    v_lshl_add_u32 v5, v21, 4, v5
    v_bfe_u32 v21, v1, 1, 1
    v_lshl_add_u32 v5, v21, 3, v5
    s_lshl_b32 s67, s57, 6
    s_lshl_b32 s68, s56, 15
    v_xor_b32 v3, s67, v5
    v_add_u32 v3, s68, v3
    v_xor_b32 v4, 64, v3
    v_bfe_u32 v21, v1, 3, 2
    v_lshlrev_b32 v21, 10, v21
    v_and_b32 v22, 7, v1
    v_lshl_add_u32 v21, v22, 7, v21
    s_add_u32 s67, s80, 65536
    v_add_u32 v21, s67, v21
    v_bfe_u32 v22, v1, 1, 3
    v_lshrrev_b32 v23, 5, v1
    v_xor_b32 v22, v22, v23
    v_xor_b32 v23, 0, v22
    v_lshl_add_u32 v13, v23, 4, v21
    v_xor_b32 v23, 2, v22
    v_lshl_add_u32 v14, v23, 4, v21
    v_xor_b32 v23, 4, v22
    v_lshl_add_u32 v15, v23, 4, v21
    v_xor_b32 v23, 6, v22
    v_lshl_add_u32 v16, v23, 4, v21
    v_and_b32 v21, 3, v1
    v_bfe_u32 v22, v1, 2, 1
    v_bfe_u32 v23, v1, 4, 1
    v_xor_b32 v22, v22, v23
    v_or_b32 v21, v21, v22
    v_cmp_eq_u32 vcc, 0, v21
    v_mov_b32 v22, s65
    s_nop 0
    v_cndmask_b32 v244, 0, v22, vcc
    v_cndmask_b32 v245, 0, v22, vcc
    v_cndmask_b32 v246, 0, v22, vcc
    v_cndmask_b32 v247, 0, v22, vcc
    s_lshl_b32 s67, s58, 6
    s_lshl_b32 s68, s55, 5
    s_add_u32 s67, s67, s68
    s_lshl_b32 s67, s67, 10
    s_lshl_b32 s68, s94, 7
    s_waitcnt lgkmcnt(0)
    s_lshl_b32 s69, s57, 6
    s_add_u32 s68, s68, s69
    v_and_b32 v27, 31, v1
    v_lshrrev_b32 v248, 5, v1
    v_lshlrev_b32 v248, 4, v248
    v_add_u32 v248, s68, v248
    v_lshl_add_u32 v27, v27, 10, v248
    v_add_u32 v27, s67, v27
    s_lshl_b32 s67, s59, 6
    s_lshl_b32 s68, s58, 1
    s_add_u32 s67, s67, s68
    s_add_u32 s67, s67, s55
    s_lshl_b32 s68, s67, 1
    v_mov_b32 v249, s68
    s_lshl_b32 s67, s67, 12
    s_lshl_b32 s68, s56, 11
    s_add_u32 s93, s67, s68
    v_and_b32 v21, 31, v1
    s_lshl_b32 s67, s54, 8
    s_add_u32 s67, s67, 159744
    v_lshl_add_u32 v22, v21, 3, s67
    v_xor_b32 v17, 512, v22
    s_add_u32 s67, s80, 65536
    v_add_u32 v23, s67, v2
    v_xor_b32 v26, 32768, v23
    s_lshl_b32 s67, s57, 8
    s_lshl_b32 s68, s56, 7
    s_add_u32 s68, s68, s67
    s_add_u32 s68, s68, 160768
    v_lshl_add_u32 v24, v21, 2, s68
    s_add_u32 s67, s67, 160768
    v_add_u32 v25, s67, v20
    s_lshl_b32 s67, s58, 1
    s_add_u32 s67, s67, s55
    s_lshl_b32 s67, s67, 15
    s_lshl_b32 s68, s59, 12
    s_add_u32 s68, s67, s68
    s_lshl_b32 s69, s57, 11
    s_add_u32 s89, s68, s69
    s_lshl_b32 s68, s56, 14
    s_add_u32 s67, s67, s68
    s_add_u32 s92, s67, 1048576
    s_mul_i32 s67, s54, 7
    s_lshl_b32 s69, s94, 7
    s_add_u32 s68, s67, 0
    s_lshr_b32 s72, s68, 1
    s_lshl_b32 s72, s72, 17
    s_and_b32 s68, s68, 1
    s_lshl_b32 s68, s68, 14
    s_add_u32 s72, s72, s68
    s_add_u32 s72, s72, s69
    s_add_u32 s68, s67, 1
    s_lshr_b32 s73, s68, 1
    s_lshl_b32 s73, s73, 17
    s_and_b32 s68, s68, 1
    s_lshl_b32 s68, s68, 14
    s_add_u32 s73, s73, s68
    s_add_u32 s73, s73, s69
    s_add_u32 s68, s67, 2
    s_lshr_b32 s74, s68, 1
    s_lshl_b32 s74, s74, 17
    s_and_b32 s68, s68, 1
    s_lshl_b32 s68, s68, 14
    s_add_u32 s74, s74, s68
    s_add_u32 s74, s74, s69
    s_add_u32 s68, s67, 3
    s_lshr_b32 s75, s68, 1
    s_lshl_b32 s75, s75, 17
    s_and_b32 s68, s68, 1
    s_lshl_b32 s68, s68, 14
    s_add_u32 s75, s75, s68
    s_add_u32 s75, s75, s69
    s_add_u32 s68, s67, 4
    s_lshr_b32 s76, s68, 1
    s_lshl_b32 s76, s76, 17
    s_and_b32 s68, s68, 1
    s_lshl_b32 s68, s68, 14
    s_add_u32 s76, s76, s68
    s_add_u32 s76, s76, s69
    s_add_u32 s68, s67, 5
    s_lshr_b32 s77, s68, 1
    s_lshl_b32 s77, s77, 17
    s_and_b32 s68, s68, 1
    s_lshl_b32 s68, s68, 14
    s_add_u32 s77, s77, s68
    s_add_u32 s77, s77, s69
    s_add_u32 s68, s67, 6
    s_lshr_b32 s78, s68, 1
    s_lshl_b32 s78, s78, 17
    s_and_b32 s68, s68, 1
    s_lshl_b32 s68, s68, 14
    s_add_u32 s78, s78, s68
    s_add_u32 s78, s78, s69
    s_sub_u32 s67, s94, s59
    s_lshl_b32 s67, s67, 7
    s_add_u32 s0, s81, s67
    v_mov_b32 v212, s64
    v_mov_b32 v213, s64
    v_mov_b32 v214, s64
    v_mov_b32 v215, s64
    s_add_u32 s1, s79, 131072
    v_min_u32 v255, 1, v1
    v_lshlrev_b32 v255, 30, v255
    v_lshrrev_b32 v18, 3, v1
    v_mul_u32_u24 v18, 130944, v18
    v_add_u32 v18, v18, v2
    s_mov_b64 exec, 0xffff
    buffer_store_dwordx4 v[212:215], v18, s[40:43], s79 offen sc1
    s_mov_b64 exec, -1
    s_waitcnt vmcnt(6)
    s_add_u32 m0, s80, 69632
    s_nop 0
    buffer_load_dwordx4 v9, s[4:7], s47 offen  lds
    buffer_load_dwordx4 v10, s[4:7], s47 offen offset:1024  lds
    s_waitcnt vmcnt(6)
    s_add_u32 m0, s80, 71680
    s_nop 0
    buffer_load_dwordx4 v11, s[4:7], s47 offen  lds
    buffer_load_dwordx4 v12, s[4:7], s47 offen offset:1024  lds
    s_waitcnt vmcnt(6)
    s_add_u32 m0, s82, 8192
    s_lshl_b32 s84, s47, 9
    s_add_u32 s84, s84, s81
    buffer_load_dwordx4 v7, s[20:23], s84 offen  lds
    buffer_load_dwordx4 v6, s[20:23], s84 offen offset:1024  lds
    s_waitcnt vmcnt(7)
    s_barrier
    s_add_u32 m0, s82, 10240
    s_lshl_b32 s84, s47, 9
    s_add_u32 s84, s84, s81
    s_add_u32 s84, s84, 16384
    buffer_load_dwordx4 v7, s[20:23], s84 offen  lds
    buffer_load_dwordx4 v6, s[20:23], s84 offen offset:1024  lds
    ds_read_b128 v[48:51], v13 offset:0
    ds_read_b128 v[52:55], v14 offset:0
    ds_read_b128 v[56:59], v15 offset:0
    ds_read_b128 v[60:63], v16 offset:0
    ds_read_b64_tr_b16 v[180:181], v4 offset:0
    ds_read_b64_tr_b16 v[182:183], v4 offset:512
    ds_read_b64_tr_b16 v[188:189], v4 offset:2048
    ds_read_b64_tr_b16 v[190:191], v4 offset:2560
    ds_read_b64_tr_b16 v[196:197], v4 offset:4096
    ds_read_b64_tr_b16 v[198:199], v4 offset:4608
    ds_read_b64_tr_b16 v[204:205], v4 offset:6144
    ds_read_b64_tr_b16 v[206:207], v4 offset:6656
    ds_read_b64_tr_b16 v[176:177], v3 offset:0
    ds_read_b64_tr_b16 v[178:179], v3 offset:512
    ds_read_b64_tr_b16 v[184:185], v3 offset:2048
    ds_read_b64_tr_b16 v[186:187], v3 offset:2560
    ds_read_b64_tr_b16 v[192:193], v3 offset:4096
    s_add_u32 m0, s80, 73728
    s_nop 0
    buffer_load_dwordx4 v9, s[4:7], s3 offen  lds
    buffer_load_dwordx4 v10, s[4:7], s3 offen offset:1024  lds
    ds_read_b64_tr_b16 v[194:195], v3 offset:4608
    ds_read_b64_tr_b16 v[200:201], v3 offset:6144
    ds_read_b64_tr_b16 v[202:203], v3 offset:6656
    s_waitcnt lgkmcnt(15)
    v_dot2_f32_bf16 v208, v48, s65, 0
    v_dot2_f32_bf16 v209, v48, v48, 0
    v_dot2_f32_bf16 v210, v49, s65, 0
    v_dot2_f32_bf16 v211, v49, v49, 0
    v_dot2c_f32_bf16 v208, s65, v50
    v_dot2c_f32_bf16 v209, v50, v50
    v_dot2c_f32_bf16 v210, s65, v51
    v_dot2c_f32_bf16 v211, v51, v51
    v_dot2c_f32_bf16 v208, s65, v52
    v_dot2c_f32_bf16 v209, v52, v52
    v_dot2c_f32_bf16 v210, s65, v53
    v_dot2c_f32_bf16 v211, v53, v53
    v_dot2c_f32_bf16 v208, s65, v54
    v_dot2c_f32_bf16 v209, v54, v54
    v_dot2c_f32_bf16 v210, s65, v55
    v_dot2c_f32_bf16 v211, v55, v55
    v_dot2c_f32_bf16 v208, s65, v56
    v_dot2c_f32_bf16 v209, v56, v56
    s_add_u32 m0, s80, 75776
    s_nop 0
    buffer_load_dwordx4 v11, s[4:7], s3 offen  lds
    buffer_load_dwordx4 v12, s[4:7], s3 offen offset:1024  lds
    v_dot2c_f32_bf16 v210, s65, v57
    v_dot2c_f32_bf16 v211, v57, v57
    v_dot2c_f32_bf16 v208, s65, v58
    v_dot2c_f32_bf16 v209, v58, v58
    v_dot2c_f32_bf16 v210, s65, v59
    v_dot2c_f32_bf16 v211, v59, v59
    v_dot2c_f32_bf16 v208, s65, v60
    v_dot2c_f32_bf16 v209, v60, v60
    v_dot2c_f32_bf16 v210, s65, v61
    v_dot2c_f32_bf16 v211, v61, v61
    v_dot2c_f32_bf16 v208, s65, v62
    v_dot2c_f32_bf16 v209, v62, v62
    v_dot2c_f32_bf16 v210, s65, v63
    v_dot2c_f32_bf16 v211, v63, v63
    s_waitcnt lgkmcnt(14)
    v_mfma_f32_32x32x16_bf16 v[128:143], v[180:183], v[48:51], 0
    s_waitcnt lgkmcnt(12)
    v_mfma_f32_32x32x16_bf16 v[128:143], v[188:191], v[52:55], v[128:143]
    s_add_u32 m0, s82, 16384
    s_lshl_b32 s84, s3, 9
    s_add_u32 s84, s84, s81
    buffer_load_dwordx4 v7, s[20:23], s84 offen  lds
    buffer_load_dwordx4 v6, s[20:23], s84 offen offset:1024  lds
    s_waitcnt vmcnt(6)
    s_barrier
    s_add_u32 m0, s82, 18432
    s_lshl_b32 s84, s3, 9
    s_add_u32 s84, s84, s81
    s_add_u32 s84, s84, 16384
    buffer_load_dwordx4 v7, s[20:23], s84 offen  lds
    buffer_load_dwordx4 v6, s[20:23], s84 offen offset:1024  lds
    ds_read_b128 v[64:67], v13 offset:4096
    ds_read_b128 v[68:71], v14 offset:4096
    s_waitcnt lgkmcnt(12)
    v_mfma_f32_32x32x16_bf16 v[128:143], v[196:199], v[56:59], v[128:143]
    ds_read_b128 v[72:75], v15 offset:4096
    ds_read_b128 v[76:79], v16 offset:4096
    s_waitcnt lgkmcnt(12)
    v_mfma_f32_32x32x16_bf16 v[128:143], v[204:207], v[60:63], v[128:143]
    s_add_u32 m0, s80, 77824
    s_nop 0
    buffer_load_dwordx4 v9, s[4:7], s95 offen  lds
    ds_read_b64_tr_b16 v[84:85], v4 offset:8192
    buffer_load_dwordx4 v10, s[4:7], s95 offen offset:1024  lds
    ds_read_b64_tr_b16 v[86:87], v4 offset:8704
    s_waitcnt lgkmcnt(12)
    v_mfma_f32_16x16x32_bf16 v[144:147], v[244:247], v[176:179], 0
    ds_read_b64_tr_b16 v[92:93], v4 offset:10240
    ds_read_b64_tr_b16 v[94:95], v4 offset:10752
    s_waitcnt lgkmcnt(12)
    v_mfma_f32_16x16x32_bf16 v[144:147], v[244:247], v[184:187], v[144:147]
    ds_read_b64_tr_b16 v[100:101], v4 offset:12288
    ds_read_b64_tr_b16 v[102:103], v4 offset:12800
    ds_read_b64_tr_b16 v[108:109], v4 offset:14336
    s_waitcnt lgkmcnt(13)
    v_mfma_f32_16x16x32_bf16 v[144:147], v[244:247], v[192:195], v[144:147]
    ds_read_b64_tr_b16 v[110:111], v4 offset:14848
    ds_read_b64_tr_b16 v[80:81], v3 offset:8192
    s_waitcnt lgkmcnt(13)
    v_mfma_f32_16x16x32_bf16 v[144:147], v[244:247], v[200:203], v[144:147]
    ds_read_b64_tr_b16 v[82:83], v3 offset:8704
    ds_read_b64_tr_b16 v[88:89], v3 offset:10240
    v_mfma_f32_32x32x16_bf16 v[112:127], v[176:179], v[48:51], 0
    ds_read_b64_tr_b16 v[90:91], v3 offset:10752
    ds_read_b64_tr_b16 v[96:97], v3 offset:12288
    v_mfma_f32_32x32x16_bf16 v[112:127], v[184:187], v[52:55], v[112:127]
    s_add_u32 m0, s80, 79872
    s_nop 0
    buffer_load_dwordx4 v11, s[4:7], s95 offen  lds
    ds_read_b64_tr_b16 v[98:99], v3 offset:12800
    buffer_load_dwordx4 v12, s[4:7], s95 offen offset:1024  lds
    ds_read_b64_tr_b16 v[104:105], v3 offset:14336
    v_mfma_f32_32x32x16_bf16 v[112:127], v[192:195], v[56:59], v[112:127]
    ds_read_b64_tr_b16 v[106:107], v3 offset:14848
    v_mfma_f32_32x32x16_bf16 v[112:127], v[200:203], v[60:63], v[112:127]
    s_waitcnt lgkmcnt(15)
    v_dot2c_f32_bf16 v208, s65, v64
    s_add_u32 m0, s82, 24576
    s_lshl_b32 s84, s95, 9
    s_add_u32 s84, s84, s81
    buffer_load_dwordx4 v7, s[20:23], s84 offen  lds
    buffer_load_dwordx4 v6, s[20:23], s84 offen offset:1024  lds
    v_dot2c_f32_bf16 v209, v64, v64
    v_dot2c_f32_bf16 v210, s65, v65
    v_dot2c_f32_bf16 v211, v65, v65
    v_dot2c_f32_bf16 v208, s65, v66
    v_dot2c_f32_bf16 v209, v66, v66
    v_dot2c_f32_bf16 v210, s65, v67
    v_dot2c_f32_bf16 v211, v67, v67
    v_dot2c_f32_bf16 v208, s65, v68
    v_dot2c_f32_bf16 v209, v68, v68
    v_dot2c_f32_bf16 v210, s65, v69
    v_dot2c_f32_bf16 v211, v69, v69
    v_dot2c_f32_bf16 v208, s65, v70
    v_dot2c_f32_bf16 v209, v70, v70
    v_dot2c_f32_bf16 v210, s65, v71
    v_dot2c_f32_bf16 v211, v71, v71
    v_dot2c_f32_bf16 v208, s65, v72
    v_dot2c_f32_bf16 v209, v72, v72
    s_add_u32 m0, s82, 26624
    s_lshl_b32 s84, s95, 9
    s_add_u32 s84, s84, s81
    s_add_u32 s84, s84, 16384
    buffer_load_dwordx4 v7, s[20:23], s84 offen  lds
    buffer_load_dwordx4 v6, s[20:23], s84 offen offset:1024  lds
    v_dot2c_f32_bf16 v210, s65, v73
    v_dot2c_f32_bf16 v211, v73, v73
    v_dot2c_f32_bf16 v208, s65, v74
    s_mul_i32 s84, s54, 2304
    s_add_u32 s84, s84, 148480
    s_cmp_eq_u32 s54, 0
    s_cselect_b32 m0, 131072, s84
    s_cselect_b32 s84, 0, 2097152
    buffer_load_dwordx4 v251, s[8:11], s84 offen nt lds
    s_lshl_b32 s84, s63, 2
    s_add_u32 s84, s84, s54
    s_lshl_b32 s84, s84, 7
    v_and_b32 v251, 15, v1
    v_lshl_add_u32 v251, v251, 3, s84
    global_load_dwordx2 v[252:253], v251, s[48:49]
    v_dot2c_f32_bf16 v209, v74, v74
    v_dot2c_f32_bf16 v210, s65, v75
    v_dot2c_f32_bf16 v211, v75, v75
    v_dot2c_f32_bf16 v208, s65, v76
    v_dot2c_f32_bf16 v209, v76, v76
    v_dot2c_f32_bf16 v210, s65, v77
    v_dot2c_f32_bf16 v211, v77, v77
    v_dot2c_f32_bf16 v208, s65, v78
    v_dot2c_f32_bf16 v209, v78, v78
    v_dot2c_f32_bf16 v210, s65, v79
    v_dot2c_f32_bf16 v211, v79, v79
    s_waitcnt lgkmcnt(14)
    v_mfma_f32_32x32x16_bf16 v[128:143], v[84:87], v[64:67], v[128:143]
    s_lshl_b32 s84, s54, 11
    s_add_u32 m0, s84, 132096
    s_lshl_b32 s84, s54, 14
    s_waitcnt lgkmcnt(12)
    v_mfma_f32_32x32x16_bf16 v[128:143], v[92:95], v[68:71], v[128:143]
    buffer_load_dwordx4 v250, s[8:11], s84 offen nt lds
    s_add_u32 s84, s84, 7168
    buffer_load_dwordx4 v250, s[8:11], s84 offen offset:1024 nt lds
    s_waitcnt vmcnt(12)
    s_barrier
    ds_read_b128 v[48:51], v13 offset:8192
    ds_read_b128 v[52:55], v14 offset:8192
    s_waitcnt lgkmcnt(12)
    v_mfma_f32_32x32x16_bf16 v[128:143], v[100:103], v[72:75], v[128:143]
    s_lshl_b32 s84, s54, 11
    s_add_u32 m0, s84, 140288
    s_lshl_b32 s84, s54, 14
    ds_read_b128 v[56:59], v15 offset:8192
    ds_read_b128 v[60:63], v16 offset:8192
    s_waitcnt lgkmcnt(12)
    v_mfma_f32_32x32x16_bf16 v[128:143], v[108:111], v[76:79], v[128:143]
    buffer_load_dwordx4 v250, s[12:15], s84 offen nt lds
    ds_read_b64_tr_b16 v[180:181], v4 offset:16384
    s_add_u32 s84, s84, 7168
    buffer_load_dwordx4 v250, s[12:15], s84 offen offset:1024 nt lds
    ds_read_b64_tr_b16 v[182:183], v4 offset:16896
    s_lshl_b32 s84, s2, 2
    s_add_u32 s84, s84, s54
    s_mul_i32 s84, s84, 512
    s_mov_b64 exec, 15
    buffer_load_dword a255, v243, s[24:27], s84 offen
    s_mov_b64 exec, -1
    s_lshr_b32 s84, s2, 3
    s_lshl_b32 s84, s84, 2
    s_add_u32 s84, s84, s54
    s_mul_i32 s84, s84, 4096
    v_lshlrev_b32 v212, 10, v1
    s_mov_b64 exec, 15
    buffer_load_dword a255, v212, s[24:27], s84 offen offset:384
    s_mov_b64 exec, -1
    s_waitcnt lgkmcnt(12)
    v_mfma_f32_16x16x32_bf16 v[144:147], v[244:247], v[80:83], v[144:147]
    ds_read_b64_tr_b16 v[188:189], v4 offset:18432
    ds_read_b64_tr_b16 v[190:191], v4 offset:18944
    s_waitcnt lgkmcnt(12)
    v_mfma_f32_16x16x32_bf16 v[144:147], v[244:247], v[88:91], v[144:147]
    ds_read_b64_tr_b16 v[196:197], v4 offset:20480
    ds_read_b64_tr_b16 v[198:199], v4 offset:20992
    ds_read_b64_tr_b16 v[204:205], v4 offset:22528
    s_waitcnt lgkmcnt(13)
    v_mfma_f32_16x16x32_bf16 v[144:147], v[244:247], v[96:99], v[144:147]
    buffer_load_dwordx4 v[32:35], v27, s[4:7], 0 offen
    ds_read_b64_tr_b16 v[206:207], v4 offset:23040
    buffer_load_dwordx4 v[36:39], v27, s[4:7], 0 offen offset:32
    ds_read_b64_tr_b16 v[176:177], v3 offset:16384
    s_waitcnt lgkmcnt(13)
    v_mfma_f32_16x16x32_bf16 v[144:147], v[244:247], v[104:107], v[144:147]
    ds_read_b64_tr_b16 v[178:179], v3 offset:16896
    ds_read_b64_tr_b16 v[184:185], v3 offset:18432
    v_mfma_f32_32x32x16_bf16 v[112:127], v[80:83], v[64:67], v[112:127]
    ds_read_b64_tr_b16 v[186:187], v3 offset:18944
    ds_read_b64_tr_b16 v[192:193], v3 offset:20480
    v_mfma_f32_32x32x16_bf16 v[112:127], v[88:91], v[68:71], v[112:127]
    ds_read_b64_tr_b16 v[194:195], v3 offset:20992
    ds_read_b64_tr_b16 v[200:201], v3 offset:22528
    v_mfma_f32_32x32x16_bf16 v[112:127], v[96:99], v[72:75], v[112:127]
    ds_read_b64_tr_b16 v[202:203], v3 offset:23040
    v_mfma_f32_32x32x16_bf16 v[112:127], v[104:107], v[76:79], v[112:127]
    s_waitcnt lgkmcnt(15)
    v_dot2c_f32_bf16 v208, s65, v48
    v_dot2c_f32_bf16 v209, v48, v48
    v_dot2c_f32_bf16 v210, s65, v49
    v_dot2c_f32_bf16 v211, v49, v49
    v_dot2c_f32_bf16 v208, s65, v50
    v_dot2c_f32_bf16 v209, v50, v50
    v_dot2c_f32_bf16 v210, s65, v51
    v_dot2c_f32_bf16 v211, v51, v51
    v_dot2c_f32_bf16 v208, s65, v52
    v_dot2c_f32_bf16 v209, v52, v52
    v_dot2c_f32_bf16 v210, s65, v53
    v_dot2c_f32_bf16 v211, v53, v53
    v_dot2c_f32_bf16 v208, s65, v54
    v_dot2c_f32_bf16 v209, v54, v54
    v_dot2c_f32_bf16 v210, s65, v55
    v_dot2c_f32_bf16 v211, v55, v55
    v_dot2c_f32_bf16 v208, s65, v56
    v_dot2c_f32_bf16 v209, v56, v56
    v_dot2c_f32_bf16 v210, s65, v57
    v_dot2c_f32_bf16 v211, v57, v57
    v_dot2c_f32_bf16 v208, s65, v58
    v_dot2c_f32_bf16 v209, v58, v58
    v_dot2c_f32_bf16 v210, s65, v59
    v_dot2c_f32_bf16 v211, v59, v59
    v_dot2c_f32_bf16 v208, s65, v60
    v_dot2c_f32_bf16 v209, v60, v60
    v_dot2c_f32_bf16 v210, s65, v61
    v_dot2c_f32_bf16 v211, v61, v61
    v_dot2c_f32_bf16 v208, s65, v62
    v_dot2c_f32_bf16 v209, v62, v62
    v_dot2c_f32_bf16 v210, s65, v63
    v_dot2c_f32_bf16 v211, v63, v63
    s_waitcnt lgkmcnt(14)
    v_mfma_f32_32x32x16_bf16 v[128:143], v[180:183], v[48:51], v[128:143]
    s_waitcnt lgkmcnt(12)
    v_mfma_f32_32x32x16_bf16 v[128:143], v[188:191], v[52:55], v[128:143]
    s_waitcnt vmcnt(10)
    s_barrier
    ds_read_b128 v[64:67], v13 offset:12288
    ds_read_b128 v[68:71], v14 offset:12288
    s_waitcnt lgkmcnt(12)
    v_mfma_f32_32x32x16_bf16 v[128:143], v[196:199], v[56:59], v[128:143]
    ds_read_b128 v[72:75], v15 offset:12288
    ds_read_b128 v[76:79], v16 offset:12288
    s_waitcnt lgkmcnt(12)
    v_mfma_f32_32x32x16_bf16 v[128:143], v[204:207], v[60:63], v[128:143]
    ds_read_b64_tr_b16 v[84:85], v4 offset:24576
    ds_read_b64_tr_b16 v[86:87], v4 offset:25088
    s_waitcnt lgkmcnt(12)
    v_mfma_f32_16x16x32_bf16 v[144:147], v[244:247], v[176:179], v[144:147]
    ds_read_b64_tr_b16 v[92:93], v4 offset:26624
    ds_read_b64_tr_b16 v[94:95], v4 offset:27136
    s_waitcnt lgkmcnt(12)
    v_mfma_f32_16x16x32_bf16 v[144:147], v[244:247], v[184:187], v[144:147]
    ds_read_b64_tr_b16 v[100:101], v4 offset:28672
    ds_read_b64_tr_b16 v[102:103], v4 offset:29184
    ds_read_b64_tr_b16 v[108:109], v4 offset:30720
    s_waitcnt lgkmcnt(13)
    v_mfma_f32_16x16x32_bf16 v[144:147], v[244:247], v[192:195], v[144:147]
    ds_read_b64_tr_b16 v[110:111], v4 offset:31232
    ds_read_b64_tr_b16 v[80:81], v3 offset:24576
    s_waitcnt lgkmcnt(13)
    v_mfma_f32_16x16x32_bf16 v[144:147], v[244:247], v[200:203], v[144:147]
    ds_read_b64_tr_b16 v[82:83], v3 offset:25088
    ds_read_b64_tr_b16 v[88:89], v3 offset:26624
    v_mfma_f32_32x32x16_bf16 v[112:127], v[176:179], v[48:51], v[112:127]
    ds_read_b64_tr_b16 v[90:91], v3 offset:27136
    ds_read_b64_tr_b16 v[96:97], v3 offset:28672
    v_mfma_f32_32x32x16_bf16 v[112:127], v[184:187], v[52:55], v[112:127]
    ds_read_b64_tr_b16 v[98:99], v3 offset:29184
    ds_read_b64_tr_b16 v[104:105], v3 offset:30720
    v_mfma_f32_32x32x16_bf16 v[112:127], v[192:195], v[56:59], v[112:127]
    ds_read_b64_tr_b16 v[106:107], v3 offset:31232
    v_mfma_f32_32x32x16_bf16 v[112:127], v[200:203], v[60:63], v[112:127]
    s_waitcnt lgkmcnt(15)
    v_dot2c_f32_bf16 v208, s65, v64
    v_dot2c_f32_bf16 v209, v64, v64
    v_dot2c_f32_bf16 v210, s65, v65
    v_dot2c_f32_bf16 v211, v65, v65
    v_dot2c_f32_bf16 v208, s65, v66
    v_dot2c_f32_bf16 v209, v66, v66
    v_dot2c_f32_bf16 v210, s65, v67
    v_dot2c_f32_bf16 v211, v67, v67
    v_dot2c_f32_bf16 v208, s65, v68
    v_dot2c_f32_bf16 v209, v68, v68
    v_dot2c_f32_bf16 v210, s65, v69
    v_dot2c_f32_bf16 v211, v69, v69
    v_dot2c_f32_bf16 v208, s65, v70
    v_dot2c_f32_bf16 v209, v70, v70
    v_dot2c_f32_bf16 v210, s65, v71
    v_dot2c_f32_bf16 v211, v71, v71
    v_dot2c_f32_bf16 v208, s65, v72
    v_dot2c_f32_bf16 v209, v72, v72
    v_dot2c_f32_bf16 v210, s65, v73
    v_dot2c_f32_bf16 v211, v73, v73
    v_dot2c_f32_bf16 v208, s65, v74
    v_dot2c_f32_bf16 v209, v74, v74
    v_dot2c_f32_bf16 v210, s65, v75
    v_dot2c_f32_bf16 v211, v75, v75
    v_dot2c_f32_bf16 v208, s65, v76
    v_dot2c_f32_bf16 v209, v76, v76
    v_dot2c_f32_bf16 v210, s65, v77
    v_dot2c_f32_bf16 v211, v77, v77
    v_dot2c_f32_bf16 v208, s65, v78
    v_dot2c_f32_bf16 v209, v78, v78
    v_dot2c_f32_bf16 v210, s65, v79
    v_dot2c_f32_bf16 v211, v79, v79
    s_waitcnt lgkmcnt(14)
    v_mfma_f32_32x32x16_bf16 v[128:143], v[84:87], v[64:67], v[128:143]
    v_add_f32 v208, v208, v210
    v_add_f32 v209, v209, v211
    v_mov_b32 v210, v208
    s_waitcnt lgkmcnt(12)
    v_mfma_f32_32x32x16_bf16 v[128:143], v[92:95], v[68:71], v[128:143]
    v_mov_b32 v211, v209
    v_permlane32_swap_b32 v208, v210
    s_nop 0
    v_permlane32_swap_b32 v209, v211
    s_waitcnt lgkmcnt(10)
    v_mfma_f32_32x32x16_bf16 v[128:143], v[100:103], v[72:75], v[128:143]
    v_add_f32 v208, v208, v210
    v_add_f32 v209, v209, v211
    s_waitcnt lgkmcnt(8)
    v_mfma_f32_32x32x16_bf16 v[128:143], v[108:111], v[76:79], v[128:143]
    global_load_dwordx4 v[40:43], v248, s[52:53]
    ds_write_b64 v22, v[208:209]
    global_load_dwordx4 v[44:47], v248, s[52:53] offset:32
    s_waitcnt lgkmcnt(7)
    v_mfma_f32_16x16x32_bf16 v[144:147], v[244:247], v[80:83], v[144:147]
    global_load_ushort v237, v249, s[50:51]
    s_waitcnt lgkmcnt(5)
    v_mfma_f32_16x16x32_bf16 v[144:147], v[244:247], v[88:91], v[144:147]
    s_waitcnt lgkmcnt(3)
    v_mfma_f32_16x16x32_bf16 v[144:147], v[244:247], v[96:99], v[144:147]
    s_waitcnt lgkmcnt(1)
    v_mfma_f32_16x16x32_bf16 v[144:147], v[244:247], v[104:107], v[144:147]
    v_mfma_f32_32x32x16_bf16 v[112:127], v[80:83], v[64:67], v[112:127]
    ds_write_b128 v23, v[128:131] offset:0
    ds_write_b128 v23, v[132:135] offset:1024
    v_mfma_f32_32x32x16_bf16 v[112:127], v[88:91], v[68:71], v[112:127]
    ds_write_b128 v23, v[136:139] offset:2048
    v_mfma_f32_32x32x16_bf16 v[112:127], v[96:99], v[72:75], v[112:127]
    ds_write_b128 v23, v[140:143] offset:3072
    v_mfma_f32_32x32x16_bf16 v[112:127], v[104:107], v[76:79], v[112:127]
    ds_write_b32 v24, v144
    buffer_load_dwordx4 v[232:235], v2, s[16:19], s93 offen nt
    buffer_load_dwordx4 v[238:241], v2, s[16:19], s93 offen offset:1024 nt
    buffer_load_dword v236, v2, s[16:19], s93 offen offset:16 nt
    buffer_load_dword v242, v2, s[16:19], s93 offen offset:1040 nt
    s_lshl_b32 s84, s2, 2
    s_add_u32 s84, s84, s54
    s_mul_i32 s84, s84, 1792
    s_mov_b64 exec, 16383
    buffer_load_dword a255, v243, s[28:31], s84 offen
    s_mov_b64 exec, -1
    s_waitcnt lgkmcnt(0)
    s_barrier
    ds_read_b64 v[210:211], v17
    ds_read_b128 v[128:131], v26 offset:0
    ds_read_b128 v[132:135], v26 offset:1024
    ds_read_b128 v[136:139], v26 offset:2048
    ds_read_b128 v[140:143], v26 offset:3072
    ds_read_b128 v[176:179], v25 offset:0
    ds_read_b128 v[192:195], v25 offset:128
    ds_read_b128 v[180:183], v25 offset:32
    ds_read_b128 v[196:199], v25 offset:160
    ds_read_b128 v[184:187], v25 offset:64
    ds_read_b128 v[200:203], v25 offset:192
    ds_read_b128 v[188:191], v25 offset:96
    ds_read_b128 v[204:207], v25 offset:224
    s_waitcnt lgkmcnt(12)
    v_add_f32 v208, v208, v210
    v_add_f32 v209, v209, v211
    v_mul_f32 v31, 0xbb000000, v208
    v_mul_f32 v209, 0x3b000000, v209
    v_fma_f32 v209, -v31, v31, v209
    v_max_f32 v209, 0, v209
    v_add_f32 v209, 0x3727c5ac, v209
    v_rsq_f32 v208, v209
    v_sqrt_f32 v30, v209
    v_mul_f32 v28, 0xc0135761, v208
    v_mul_f32 v209, v208, v208
    v_mul_f32 v209, v209, v208
    v_mul_f32 v29, 0xbdd2d3e8, v209
    s_waitcnt lgkmcnt(11)
    v_pk_add_f32 v[112:113], v[112:113], v[128:129]
    v_pk_add_f32 v[114:115], v[114:115], v[130:131]
    s_waitcnt lgkmcnt(10)
    v_pk_add_f32 v[116:117], v[116:117], v[132:133]
    v_pk_add_f32 v[118:119], v[118:119], v[134:135]
    s_waitcnt lgkmcnt(9)
    v_pk_add_f32 v[120:121], v[120:121], v[136:137]
    v_pk_add_f32 v[122:123], v[122:123], v[138:139]
    s_waitcnt lgkmcnt(8)
    v_pk_add_f32 v[124:125], v[124:125], v[140:141]
    v_pk_add_f32 v[126:127], v[126:127], v[142:143]
    s_waitcnt lgkmcnt(6)
    v_pk_add_f32 v[176:177], v[176:177], v[192:193]
    v_pk_add_f32 v[178:179], v[178:179], v[194:195]
    s_waitcnt lgkmcnt(4)
    v_pk_add_f32 v[180:181], v[180:181], v[196:197]
    v_pk_add_f32 v[182:183], v[182:183], v[198:199]
    s_waitcnt lgkmcnt(2)
    v_pk_add_f32 v[184:185], v[184:185], v[200:201]
    v_pk_add_f32 v[186:187], v[186:187], v[202:203]
    s_waitcnt lgkmcnt(0)
    v_pk_add_f32 v[188:189], v[188:189], v[204:205]
    v_pk_add_f32 v[190:191], v[190:191], v[206:207]
    .p2align 3
    v_pk_fma_f32 v[112:113], v[176:177], v[30:31], v[112:113] op_sel:[0,1,0] op_sel_hi:[1,1,1]
    v_pk_fma_f32 v[114:115], v[178:179], v[30:31], v[114:115] op_sel:[0,1,0] op_sel_hi:[1,1,1]
    v_pk_fma_f32 v[116:117], v[180:181], v[30:31], v[116:117] op_sel:[0,1,0] op_sel_hi:[1,1,1]
    v_pk_fma_f32 v[118:119], v[182:183], v[30:31], v[118:119] op_sel:[0,1,0] op_sel_hi:[1,1,1]
    v_pk_mul_f32 v[224:225], v[112:113], v[112:113]
    v_pk_mul_f32 v[226:227], v[114:115], v[114:115]
    v_pk_mul_f32 v[228:229], v[116:117], v[116:117]
    v_pk_mul_f32 v[230:231], v[118:119], v[118:119]
    v_pk_fma_f32 v[224:225], v[224:225], v[28:29], v[28:29] op_sel:[0,1,0] op_sel_hi:[1,1,0]
    v_pk_fma_f32 v[226:227], v[226:227], v[28:29], v[28:29] op_sel:[0,1,0] op_sel_hi:[1,1,0]
    v_pk_fma_f32 v[228:229], v[228:229], v[28:29], v[28:29] op_sel:[0,1,0] op_sel_hi:[1,1,0]
    v_pk_fma_f32 v[230:231], v[230:231], v[28:29], v[28:29] op_sel:[0,1,0] op_sel_hi:[1,1,0]
    v_pk_mul_f32 v[224:225], v[224:225], v[112:113]
    v_pk_mul_f32 v[226:227], v[226:227], v[114:115]
    v_pk_mul_f32 v[228:229], v[228:229], v[116:117]
    v_pk_mul_f32 v[230:231], v[230:231], v[118:119]
    v_exp_f32 v224, v224
    v_exp_f32 v225, v225
    v_exp_f32 v226, v226
    v_exp_f32 v227, v227
    v_exp_f32 v228, v228
    v_exp_f32 v229, v229
    v_exp_f32 v230, v230
    v_exp_f32 v231, v231
    v_pk_fma_f32 v[224:225], v[224:225], v[30:31], v[30:31] op_sel:[0,0,0] op_sel_hi:[1,0,0]
    v_pk_fma_f32 v[226:227], v[226:227], v[30:31], v[30:31] op_sel:[0,0,0] op_sel_hi:[1,0,0]
    v_pk_fma_f32 v[228:229], v[228:229], v[30:31], v[30:31] op_sel:[0,0,0] op_sel_hi:[1,0,0]
    v_pk_fma_f32 v[230:231], v[230:231], v[30:31], v[30:31] op_sel:[0,0,0] op_sel_hi:[1,0,0]
    v_rcp_f32 v224, v224
    v_rcp_f32 v225, v225
    v_rcp_f32 v226, v226
    v_rcp_f32 v227, v227
    v_rcp_f32 v228, v228
    v_rcp_f32 v229, v229
    v_rcp_f32 v230, v230
    v_rcp_f32 v231, v231
    v_pk_mul_f32 v[224:225], v[224:225], v[112:113]
    v_pk_mul_f32 v[226:227], v[226:227], v[114:115]
    v_pk_mul_f32 v[228:229], v[228:229], v[116:117]
    v_pk_mul_f32 v[230:231], v[230:231], v[118:119]
    v_cvt_pk_bf16_f32 v216, v224, v225
    v_cvt_pk_bf16_f32 v217, v226, v227
    v_cvt_pk_bf16_f32 v218, v228, v229
    v_cvt_pk_bf16_f32 v219, v230, v231
    .p2align 3
    v_pk_fma_f32 v[120:121], v[184:185], v[30:31], v[120:121] op_sel:[0,1,0] op_sel_hi:[1,1,1]
    v_pk_fma_f32 v[122:123], v[186:187], v[30:31], v[122:123] op_sel:[0,1,0] op_sel_hi:[1,1,1]
    v_pk_fma_f32 v[124:125], v[188:189], v[30:31], v[124:125] op_sel:[0,1,0] op_sel_hi:[1,1,1]
    v_pk_fma_f32 v[126:127], v[190:191], v[30:31], v[126:127] op_sel:[0,1,0] op_sel_hi:[1,1,1]
    v_pk_mul_f32 v[224:225], v[120:121], v[120:121]
    v_pk_mul_f32 v[226:227], v[122:123], v[122:123]
    v_pk_mul_f32 v[228:229], v[124:125], v[124:125]
    v_pk_mul_f32 v[230:231], v[126:127], v[126:127]
    v_pk_fma_f32 v[224:225], v[224:225], v[28:29], v[28:29] op_sel:[0,1,0] op_sel_hi:[1,1,0]
    v_pk_fma_f32 v[226:227], v[226:227], v[28:29], v[28:29] op_sel:[0,1,0] op_sel_hi:[1,1,0]
    v_pk_fma_f32 v[228:229], v[228:229], v[28:29], v[28:29] op_sel:[0,1,0] op_sel_hi:[1,1,0]
    v_pk_fma_f32 v[230:231], v[230:231], v[28:29], v[28:29] op_sel:[0,1,0] op_sel_hi:[1,1,0]
    v_pk_mul_f32 v[224:225], v[224:225], v[120:121]
    v_pk_mul_f32 v[226:227], v[226:227], v[122:123]
    v_pk_mul_f32 v[228:229], v[228:229], v[124:125]
    v_pk_mul_f32 v[230:231], v[230:231], v[126:127]
    v_exp_f32 v224, v224
    v_exp_f32 v225, v225
    v_exp_f32 v226, v226
    v_exp_f32 v227, v227
    v_exp_f32 v228, v228
    v_exp_f32 v229, v229
    v_exp_f32 v230, v230
    v_exp_f32 v231, v231
    v_pk_fma_f32 v[224:225], v[224:225], v[30:31], v[30:31] op_sel:[0,0,0] op_sel_hi:[1,0,0]
    v_pk_fma_f32 v[226:227], v[226:227], v[30:31], v[30:31] op_sel:[0,0,0] op_sel_hi:[1,0,0]
    v_pk_fma_f32 v[228:229], v[228:229], v[30:31], v[30:31] op_sel:[0,0,0] op_sel_hi:[1,0,0]
    v_pk_fma_f32 v[230:231], v[230:231], v[30:31], v[30:31] op_sel:[0,0,0] op_sel_hi:[1,0,0]
    v_rcp_f32 v224, v224
    v_rcp_f32 v225, v225
    v_rcp_f32 v226, v226
    v_rcp_f32 v227, v227
    v_rcp_f32 v228, v228
    v_rcp_f32 v229, v229
    v_rcp_f32 v230, v230
    v_rcp_f32 v231, v231
    v_pk_mul_f32 v[224:225], v[224:225], v[120:121]
    v_pk_mul_f32 v[226:227], v[226:227], v[122:123]
    v_pk_mul_f32 v[228:229], v[228:229], v[124:125]
    v_pk_mul_f32 v[230:231], v[230:231], v[126:127]
    v_cvt_pk_bf16_f32 v220, v224, v225
    v_cvt_pk_bf16_f32 v221, v226, v227
    v_cvt_pk_bf16_f32 v222, v228, v229
    v_cvt_pk_bf16_f32 v223, v230, v231
    s_add_u32 s67, s89, 1048576
    buffer_store_dwordx4 v[216:219], v2, s[40:43], s67 offen sc1
    buffer_store_dwordx4 v[220:223], v2, s[40:43], s67 offen offset:1024 sc1
    v_lshrrev_b32 v21, 4, v1
    s_add_u32 m0, s82, 0
    s_lshl_b32 s84, s46, 9
    s_add_u32 s84, s84, s0
    buffer_load_dwordx4 v7, s[24:27], s84 offen  lds
    buffer_load_dwordx4 v6, s[24:27], s84 offen offset:1024  lds
    s_add_u32 m0, s82, 2048
    s_lshl_b32 s84, s46, 9
    s_add_u32 s84, s84, s0
    s_add_u32 s84, s84, 16384
    buffer_load_dwordx4 v7, s[24:27], s84 offen  lds
    buffer_load_dwordx4 v6, s[24:27], s84 offen offset:1024  lds
    v_lshlrev_b32 v21, 11, v21
    v_bfe_u32 v22, v1, 2, 2
    v_lshl_add_u32 v21, v22, 7, v21
    v_and_b32 v22, 3, v1
    v_lshl_add_u32 v21, v22, 3, v21
    s_lshl_b32 s67, s54, 5
    s_add_u32 s67, s67, 131072
    v_add_u32 v21, s67, v21
    s_waitcnt vmcnt(18)
    s_barrier
    ds_read_b64_tr_b16 v[48:49], v21 offset:512
    ds_read_b64_tr_b16 v[50:51], v21 offset:1024
    ds_read_b64_tr_b16 v[52:53], v21 offset:1536
    ds_read_b64_tr_b16 v[54:55], v21 offset:2048
    s_add_u32 m0, s82, 8192
    s_lshl_b32 s84, s47, 9
    s_add_u32 s84, s84, s0
    buffer_load_dwordx4 v7, s[24:27], s84 offen  lds
    buffer_load_dwordx4 v6, s[24:27], s84 offen offset:1024  lds
    ds_read_b64_tr_b16 v[56:57], v21 offset:2560
    ds_read_b64_tr_b16 v[60:61], v21 offset:9216
    ds_read_b64_tr_b16 v[62:63], v21 offset:9728
    ds_read_b64_tr_b16 v[64:65], v21 offset:10240
    ds_read_b64_tr_b16 v[66:67], v21 offset:10752
    v_alignbit_b32 v176, v252, v252, 16
    v_alignbit_b32 v177, v253, v253, 16
    v_and_b32 v178, 0xffff, v252
    v_and_b32 v180, s66, v253
    v_and_b32 v179, 0xffff, v253
    v_and_or_b32 v179, v252, s66, v179
    v_and_b32 v24, 3, v1
    v_bfe_u32 v23, v1, 2, 1
    v_lshlrev_b32 v24, 9, v24
    v_lshl_add_u32 v17, v23, 8, v24
    s_lshl_b32 s85, s58, 12
    s_lshl_b32 s68, s56, 11
    s_add_u32 s85, s85, s68
    s_lshl_b32 s68, s55, 7
    s_add_u32 s85, s85, s68
    s_waitcnt lgkmcnt(8)
    v_dot2_f32_bf16 v112, v48, v180, 0
    v_dot2_f32_bf16 v113, v49, v177, 0
    v_dot2_f32_bf16 v114, v49, v180, 0
    s_waitcnt lgkmcnt(7)
    v_dot2_f32_bf16 v115, v50, v177, 0
    v_dot2_f32_bf16 v116, v50, v180, 0
    v_dot2_f32_bf16 v117, v51, v177, 0
    v_dot2_f32_bf16 v118, v51, v180, 0
    s_waitcnt lgkmcnt(6)
    v_dot2_f32_bf16 v119, v52, v177, 0
    v_dot2_f32_bf16 v120, v52, v180, 0
    v_dot2_f32_bf16 v121, v53, v177, 0
    v_dot2_f32_bf16 v122, v53, v180, 0
    s_waitcnt lgkmcnt(5)
    v_dot2_f32_bf16 v123, v54, v177, 0
    v_dot2_f32_bf16 v124, v54, v180, 0
    v_dot2_f32_bf16 v125, v55, v177, 0
    v_dot2_f32_bf16 v126, v55, v180, 0
    s_waitcnt lgkmcnt(4)
    v_dot2_f32_bf16 v127, v56, v177, 0
    v_dot2_f32_bf16 v112, v49, v179, v112
    v_dot2_f32_bf16 v113, v50, v176, v113
    v_dot2_f32_bf16 v114, v50, v179, v114
    v_dot2_f32_bf16 v115, v51, v176, v115
    v_dot2_f32_bf16 v116, v51, v179, v116
    v_dot2_f32_bf16 v117, v52, v176, v117
    v_dot2_f32_bf16 v118, v52, v179, v118
    v_dot2_f32_bf16 v119, v53, v176, v119
    v_dot2_f32_bf16 v120, v53, v179, v120
    v_dot2_f32_bf16 v121, v54, v176, v121
    v_dot2_f32_bf16 v122, v54, v179, v122
    v_dot2_f32_bf16 v123, v55, v176, v123
    v_dot2_f32_bf16 v124, v55, v179, v124
    v_dot2_f32_bf16 v125, v56, v176, v125
    v_dot2_f32_bf16 v126, v56, v179, v126
    v_dot2_f32_bf16 v127, v57, v176, v127
    v_dot2_f32_bf16 v112, v50, v178, v112
    v_dot2_f32_bf16 v114, v51, v178, v114
    s_add_u32 m0, s82, 10240
    s_lshl_b32 s84, s47, 9
    s_add_u32 s84, s84, s0
    s_add_u32 s84, s84, 16384
    buffer_load_dwordx4 v7, s[24:27], s84 offen  lds
    buffer_load_dwordx4 v6, s[24:27], s84 offen offset:1024  lds
    v_dot2_f32_bf16 v116, v52, v178, v116
    v_dot2_f32_bf16 v118, v53, v178, v118
    v_dot2_f32_bf16 v120, v54, v178, v120
    v_dot2_f32_bf16 v122, v55, v178, v122
    v_dot2_f32_bf16 v124, v56, v178, v124
    v_dot2_f32_bf16 v126, v57, v178, v126
    s_waitcnt lgkmcnt(3)
    v_lshlrev_b32 v128, 16, v60
    v_and_b32 v129, s66, v60
    v_lshlrev_b32 v130, 16, v61
    v_and_b32 v131, s66, v61
    s_waitcnt lgkmcnt(2)
    v_lshlrev_b32 v132, 16, v62
    v_and_b32 v133, s66, v62
    v_lshlrev_b32 v134, 16, v63
    v_and_b32 v135, s66, v63
    s_waitcnt lgkmcnt(1)
    v_lshlrev_b32 v136, 16, v64
    v_and_b32 v137, s66, v64
    v_lshlrev_b32 v138, 16, v65
    v_and_b32 v139, s66, v65
    s_waitcnt lgkmcnt(0)
    v_lshlrev_b32 v140, 16, v66
    v_and_b32 v141, s66, v66
    v_lshlrev_b32 v142, 16, v67
    v_and_b32 v143, s66, v67
    v_pk_mul_f32 v[112:113], v[112:113], v[128:129]
    v_pk_mul_f32 v[114:115], v[114:115], v[130:131]
    v_pk_mul_f32 v[116:117], v[116:117], v[132:133]
    v_pk_mul_f32 v[118:119], v[118:119], v[134:135]
    v_add_u32_e64 v18, s64, 1
    s_waitcnt vmcnt(8)
    s_mov_b64 exec, 1
    buffer_store_dword v18, v255, s[40:43], s79 offen sc1
    s_mov_b64 exec, -1
    v_pk_mul_f32 v[120:121], v[120:121], v[136:137]
    v_pk_mul_f32 v[122:123], v[122:123], v[138:139]
    v_pk_mul_f32 v[124:125], v[124:125], v[140:141]
    v_pk_mul_f32 v[126:127], v[126:127], v[142:143]
    v_cvt_pk_bf16_f32 v208, v127, v126
    v_cvt_pk_bf16_f32 v209, v125, v124
    v_cvt_pk_bf16_f32 v210, v123, v122
    v_cvt_pk_bf16_f32 v211, v121, v120
    v_cvt_pk_bf16_f32 v212, v119, v118
    v_cvt_pk_bf16_f32 v213, v117, v116
    v_cvt_pk_bf16_f32 v214, v115, v114
    v_cvt_pk_bf16_f32 v215, v113, v112
    v_and_b32 v21, 15, v1
    v_mul_u32_u24 v21, 144, v21
    v_lshrrev_b32 v22, 4, v1
    v_sub_u32 v22, 3, v22
    v_lshl_add_u32 v21, v22, 5, v21
    s_mul_i32 s67, s54, 2304
    s_add_u32 s67, s67, 148480
    v_add_u32 v21, s67, v21
    s_add_u32 m0, s82, 16384
    s_lshl_b32 s84, s3, 9
    s_add_u32 s84, s84, s0
    buffer_load_dwordx4 v7, s[24:27], s84 offen  lds
    buffer_load_dwordx4 v6, s[24:27], s84 offen offset:1024  lds
    ds_write_b128 v21, v[208:211]
    ds_write_b128 v21, v[212:215] offset:16
    v_lshrrev_b32 v21, 3, v1
    v_and_b32 v22, 7, v1
    v_lshlrev_b32 v22, 4, v22
    v_lshl_add_u32 v23, v21, 12, v22
    v_mul_u32_u24 v21, 144, v21
    v_add3_u32 v21, v21, v22, s67
    s_lshl_b32 s67, s63, 18
    s_lshl_b32 s68, s54, 16
    s_add_u32 s67, s67, s68
    s_sub_u32 s68, 31, s58
    s_lshl_b32 s68, s68, 7
    s_add_u32 s67, s67, s68
    s_add_u32 s67, s67, 12582912
    s_add_u32 s68, s67, 32768
    s_waitcnt lgkmcnt(0)
    ds_read_b128 v[216:219], v21
    ds_read_b128 v[220:223], v21 offset:1152
    s_waitcnt vmcnt(8)
    s_add_u32 m0, s82, 18432
    s_lshl_b32 s84, s3, 9
    s_add_u32 s84, s84, s0
    s_add_u32 s84, s84, 16384
    buffer_load_dwordx4 v7, s[24:27], s84 offen  lds
    buffer_load_dwordx4 v6, s[24:27], s84 offen offset:1024  lds
    s_waitcnt lgkmcnt(1)
    buffer_store_dwordx4 v[216:219], v23, s[40:43], s67 offen sc1
    s_waitcnt lgkmcnt(0)
    buffer_store_dwordx4 v[220:223], v23, s[40:43], s68 offen sc1
    v_dot2_f32_bf16 v208, v32, v40, 0
    v_dot2_f32_bf16 v209, v33, v41, 0
    v_dot2_f32_bf16 v208, v34, v42, v208
    v_dot2_f32_bf16 v209, v35, v43, v209
    v_dot2_f32_bf16 v208, v36, v44, v208
    v_dot2_f32_bf16 v209, v37, v45, v209
    v_dot2_f32_bf16 v208, v38, v46, v208
    v_dot2_f32_bf16 v209, v39, v47, v209
    s_lshl_b32 s70, s58, 1
    s_add_u32 s70, s70, s55
    s_lshl_b32 s86, s70, 11
    s_lshl_b32 s68, s94, 1
    s_add_u32 s68, s68, s57
    s_lshl_b32 s68, s68, 7
    s_add_u32 s86, s86, s68
    v_lshlrev_b32 v26, 2, v1
    s_add_u32 s86, s86, 17301504
    v_add_f32 v208, v208, v209
    v_mov_b32 v209, v208
    s_nop 1
    v_permlane32_swap_b32 v208, v209
    v_add_f32 v208, v208, v209
    s_mov_b64 exec, 0xffffffff
    buffer_store_dword v208, v26, s[40:43], s86 offen sc1
    s_mov_b64 exec, -1
    s_lshl_b32 s12, s46, 5
    s_add_u32 s12, s12, s92
    s_lshl_b32 s13, s47, 5
    s_add_u32 s13, s13, s92
    s_lshl_b32 s14, s3, 5
    s_add_u32 s14, s14, s92
    s_lshl_b32 s15, s95, 5
    s_add_u32 s15, s15, s92
    v_add_u32_e64 v18, s64, 1
    s_waitcnt vmcnt(8)
    s_add_u32 m0, s82, 24576
    s_lshl_b32 s84, s95, 9
    s_add_u32 s84, s84, s0
    buffer_load_dwordx4 v7, s[24:27], s84 offen  lds
    buffer_load_dwordx4 v6, s[24:27], s84 offen offset:1024  lds
    s_waitcnt vmcnt(8)
    s_add_u32 m0, s82, 26624
    s_lshl_b32 s84, s95, 9
    s_add_u32 s84, s84, s0
    s_add_u32 s84, s84, 16384
    buffer_load_dwordx4 v7, s[24:27], s84 offen  lds
    buffer_load_dwordx4 v6, s[24:27], s84 offen offset:1024  lds
    s_waitcnt vmcnt(5)
    s_mov_b64 exec, 1
    buffer_store_dword v18, v255, s[40:43], s1 offen sc1
    s_mov_b64 exec, -1
    s_waitcnt vmcnt(1)
    buffer_load_dword v248, v17, s[40:43], s85 offen sc1
    s_add_u32 s87, s64, 1
    s_waitcnt vmcnt(0)
    v_subrev_u32 v248, s87, v248
    v_cmp_lt_u32 vcc, 5, v248
    s_cbranch_vccz L_pdone_2
    s_mov_b32 s71, 400000
L_poll_1:
    s_sleep 3
    s_sub_u32 s71, s71, 1
    buffer_load_dword v248, v17, s[40:43], s85 offen sc1
    s_waitcnt vmcnt(0)
    v_subrev_u32 v248, s87, v248
    v_cmp_lt_u32 vcc, 5, v248
    s_cbranch_vccz L_pdone_2
    s_cmp_lg_u32 s71, 0
    s_cbranch_scc1 L_poll_1
L_pdone_2:
    v_and_b32 v250, 31, v1
    buffer_load_dwordx4 v[48:51], v2, s[40:43], s12 offen offset:0 sc1
    buffer_load_dwordx4 v[52:55], v2, s[40:43], s12 offen offset:1024 sc1
    buffer_load_dwordx4 v[56:59], v2, s[40:43], s12 offen offset:2048 sc1
    buffer_load_dwordx4 v[60:63], v2, s[40:43], s12 offen offset:3072 sc1
    v_lshlrev_b32 v250, 12, v250
    s_sub_u32 s86, s59, 2
    s_and_b32 s86, s86, 7
    s_lshl_b32 s86, s86, 9
    s_lshr_b32 s70, s58, 3
    s_lshl_b32 s70, s70, 7
    s_add_u32 s86, s86, s70
    s_add_u32 s86, s86, 131072
    s_add_u32 s70, s80, 77824
    v_add_u32 v23, s70, v2
    buffer_load_dwordx4 v[64:67], v2, s[40:43], s13 offen offset:0 sc1
    buffer_load_dwordx4 v[68:71], v2, s[40:43], s13 offen offset:1024 sc1
    v_xor_b32 v24, 32768, v23
    s_sub_u32 s67, s94, s59
    s_lshl_b32 s67, s67, 12
    s_add_u32 s67, s67, s89
    s_add_u32 s89, s67, 3145728
    s_lshl_b32 s70, s58, 1
    s_add_u32 s70, s70, s55
    s_lshl_b32 s85, s70, 12
    s_lshl_b32 s68, s94, 9
    s_add_u32 s85, s85, s68
    s_lshl_b32 s68, s57, 8
    s_add_u32 s85, s85, s68
    s_add_u32 s85, s85, 16777216
    v_lshlrev_b32 v251, 3, v1
    s_barrier
    ds_read_b64_tr_b16 v[180:181], v4 offset:0
    ds_read_b64_tr_b16 v[182:183], v4 offset:512
    ds_read_b64_tr_b16 v[176:177], v3 offset:0
    ds_read_b64_tr_b16 v[178:179], v3 offset:512
    ds_read_b64_tr_b16 v[188:189], v4 offset:2048
    ds_read_b64_tr_b16 v[190:191], v4 offset:2560
    ds_read_b64_tr_b16 v[184:185], v3 offset:2048
    ds_read_b64_tr_b16 v[186:187], v3 offset:2560
    ds_read_b64_tr_b16 v[196:197], v4 offset:4096
    ds_read_b64_tr_b16 v[198:199], v4 offset:4608
    ds_read_b64_tr_b16 v[192:193], v3 offset:4096
    ds_read_b64_tr_b16 v[194:195], v3 offset:4608
    s_mul_i32 s67, s55, 8576
    s_add_u32 s67, s67, 131072
    s_lshl_b32 s68, s56, 11
    s_add_u32 s68, s68, s67
    v_add_u32 v21, s68, v2
    buffer_load_dwordx4 v[72:75], v2, s[40:43], s13 offen offset:2048 sc1
    buffer_load_dwordx4 v[76:79], v2, s[40:43], s13 offen offset:3072 sc1
    v_cmp_eq_u32 vcc, 63, v1
    s_cmp_eq_u32 s56, 1
    s_cselect_b64 vcc, vcc, 0
    v_cndmask_b32 v242, v242, v19, vcc
    ds_write_b128 v21, v[232:235] offset:64
    ds_write_b128 v21, v[238:241] offset:1088
    v_alignbit_b32 v216, v233, v232, 16
    v_alignbit_b32 v220, v239, v238, 16
    v_alignbit_b32 v217, v234, v233, 16
    v_alignbit_b32 v221, v240, v239, 16
    v_alignbit_b32 v218, v235, v234, 16
    v_alignbit_b32 v222, v241, v240, 16
    v_alignbit_b32 v219, v236, v235, 16
    v_alignbit_b32 v223, v242, v241, 16
    ds_write_b128 v21, v[216:219] offset:4352
    ds_write_b128 v21, v[220:223] offset:5376
    s_mul_i32 s68, s56, 4160
    s_add_u32 s68, s68, s67
    v_and_b32 v22, 15, v1
    v_lshl_add_u32 v21, v22, 2, s68
    v_readfirstlane_b32 s69, v232
    s_lshl_b32 s69, s69, 16
    s_cmp_eq_u32 s56, 0
    s_cselect_b32 s69, s69, 0
    v_cmp_eq_u32 vcc, 15, v22
    v_mov_b32 v22, s69
    s_nop 0
    v_cndmask_b32 v22, 0, v22, vcc
    ds_write_b32 v21, v19
    ds_write_b32 v21, v22 offset:4288
    s_mul_i32 s67, s55, 4928
    s_add_u32 s67, s67, 148224
    s_lshl_b32 s68, s56, 8
    s_add_u32 s68, s68, s67
    v_lshl_add_u32 v21, v1, 2, s68
    buffer_load_dwordx4 v[80:83], v2, s[40:43], s14 offen offset:0 sc1
    buffer_load_dwordx4 v[84:87], v2, s[40:43], s14 offen offset:1024 sc1
    v_and_b32 v22, 7, v1
    v_lshl_add_u32 v22, v22, 2, s67
    ds_write_b32 v21, v19 offset:4128
    ds_write_b32 v21, v19 offset:4384
    ds_write_b32 v22, v19
    s_waitcnt vmcnt(9) lgkmcnt(15)
    v_mfma_f32_32x32x16_bf16 v[128:143], v[180:183], v[48:51], 0
    ds_read_b64_tr_b16 v[204:205], v4 offset:6144
    ds_read_b64_tr_b16 v[206:207], v4 offset:6656
    v_mfma_f32_32x32x16_bf16 v[112:127], v[176:179], v[48:51], 0
    ds_read_b64_tr_b16 v[200:201], v3 offset:6144
    ds_read_b64_tr_b16 v[202:203], v3 offset:6656
    s_waitcnt vmcnt(8)
    v_mfma_f32_32x32x16_bf16 v[128:143], v[188:191], v[52:55], v[128:143]
    buffer_load_dwordx4 v[88:91], v2, s[40:43], s14 offen offset:2048 sc1
    ds_read_b64_tr_b16 v[180:181], v4 offset:8192
    buffer_load_dwordx4 v[92:95], v2, s[40:43], s14 offen offset:3072 sc1
    ds_read_b64_tr_b16 v[182:183], v4 offset:8704
    s_waitcnt lgkmcnt(15)
    v_mfma_f32_32x32x16_bf16 v[112:127], v[184:187], v[52:55], v[112:127]
    ds_read_b64_tr_b16 v[176:177], v3 offset:8192
    ds_read_b64_tr_b16 v[178:179], v3 offset:8704
    s_waitcnt vmcnt(9)
    v_mfma_f32_32x32x16_bf16 v[128:143], v[196:199], v[56:59], v[128:143]
    ds_read_b64_tr_b16 v[188:189], v4 offset:10240
    ds_read_b64_tr_b16 v[190:191], v4 offset:10752
    v_mfma_f32_32x32x16_bf16 v[112:127], v[192:195], v[56:59], v[112:127]
    ds_read_b64_tr_b16 v[184:185], v3 offset:10240
    ds_read_b64_tr_b16 v[186:187], v3 offset:10752
    s_waitcnt vmcnt(8) lgkmcnt(10)
    v_mfma_f32_32x32x16_bf16 v[128:143], v[204:207], v[60:63], v[128:143]
    buffer_load_dwordx4 v[96:99], v2, s[40:43], s15 offen offset:0 sc1
    ds_read_b64_tr_b16 v[196:197], v4 offset:12288
    buffer_load_dwordx4 v[100:103], v2, s[40:43], s15 offen offset:1024 sc1
    ds_read_b64_tr_b16 v[198:199], v4 offset:12800
    s_waitcnt lgkmcnt(10)
    v_mfma_f32_32x32x16_bf16 v[112:127], v[200:203], v[60:63], v[112:127]
    ds_read_b64_tr_b16 v[192:193], v3 offset:12288
    ds_read_b64_tr_b16 v[194:195], v3 offset:12800
    s_waitcnt vmcnt(9) lgkmcnt(10)
    v_mfma_f32_32x32x16_bf16 v[128:143], v[180:183], v[64:67], v[128:143]
    ds_read_b64_tr_b16 v[204:205], v4 offset:14336
    ds_read_b64_tr_b16 v[206:207], v4 offset:14848
    s_waitcnt lgkmcnt(10)
    v_mfma_f32_32x32x16_bf16 v[112:127], v[176:179], v[64:67], v[112:127]
    ds_read_b64_tr_b16 v[200:201], v3 offset:14336
    ds_read_b64_tr_b16 v[202:203], v3 offset:14848
    s_waitcnt vmcnt(8) lgkmcnt(10)
    v_mfma_f32_32x32x16_bf16 v[128:143], v[188:191], v[68:71], v[128:143]
    buffer_load_dwordx4 v[104:107], v2, s[40:43], s15 offen offset:2048 sc1
    ds_read_b64_tr_b16 v[180:181], v4 offset:16384
    buffer_load_dwordx4 v[108:111], v2, s[40:43], s15 offen offset:3072 sc1
    ds_read_b64_tr_b16 v[182:183], v4 offset:16896
    s_waitcnt lgkmcnt(10)
    v_mfma_f32_32x32x16_bf16 v[112:127], v[184:187], v[68:71], v[112:127]
    ds_read_b64_tr_b16 v[176:177], v3 offset:16384
    ds_read_b64_tr_b16 v[178:179], v3 offset:16896
    s_waitcnt vmcnt(9) lgkmcnt(10)
    v_mfma_f32_32x32x16_bf16 v[128:143], v[196:199], v[72:75], v[128:143]
    ds_read_b64_tr_b16 v[188:189], v4 offset:18432
    ds_read_b64_tr_b16 v[190:191], v4 offset:18944
    s_waitcnt lgkmcnt(10)
    v_mfma_f32_32x32x16_bf16 v[112:127], v[192:195], v[72:75], v[112:127]
    ds_read_b64_tr_b16 v[184:185], v3 offset:18432
    ds_read_b64_tr_b16 v[186:187], v3 offset:18944
    s_waitcnt vmcnt(8) lgkmcnt(10)
    v_mfma_f32_32x32x16_bf16 v[128:143], v[204:207], v[76:79], v[128:143]
    s_add_u32 m0, s80, 65536
    s_add_u32 s84, s83, 0
    ds_read_b64_tr_b16 v[196:197], v4 offset:20480
    ds_read_b64_tr_b16 v[198:199], v4 offset:20992
    s_waitcnt lgkmcnt(10)
    v_mfma_f32_32x32x16_bf16 v[112:127], v[200:203], v[76:79], v[112:127]
    buffer_load_dwordx4 v8, s[28:31], s84 offen  lds
    buffer_load_dwordx4 v0, s[28:31], s84 offen offset:1024  lds
    ds_read_b64_tr_b16 v[192:193], v3 offset:20480
    ds_read_b64_tr_b16 v[194:195], v3 offset:20992
    s_waitcnt vmcnt(9) lgkmcnt(10)
    v_mfma_f32_32x32x16_bf16 v[128:143], v[180:183], v[80:83], v[128:143]
    ds_read_b64_tr_b16 v[204:205], v4 offset:22528
    ds_read_b64_tr_b16 v[206:207], v4 offset:23040
    s_waitcnt lgkmcnt(10)
    v_mfma_f32_32x32x16_bf16 v[112:127], v[176:179], v[80:83], v[112:127]
    ds_read_b64_tr_b16 v[200:201], v3 offset:22528
    ds_read_b64_tr_b16 v[202:203], v3 offset:23040
    s_waitcnt vmcnt(8) lgkmcnt(10)
    v_mfma_f32_32x32x16_bf16 v[128:143], v[188:191], v[84:87], v[128:143]
    s_add_u32 m0, s80, 67584
    s_add_u32 s84, s83, 57344
    ds_read_b64_tr_b16 v[180:181], v4 offset:24576
    ds_read_b64_tr_b16 v[182:183], v4 offset:25088
    s_waitcnt lgkmcnt(10)
    v_mfma_f32_32x32x16_bf16 v[112:127], v[184:187], v[84:87], v[112:127]
    buffer_load_dwordx4 v8, s[28:31], s84 offen  lds
    ds_read_b64_tr_b16 v[176:177], v3 offset:24576
    buffer_load_dwordx4 v0, s[28:31], s84 offen offset:1024  lds
    ds_read_b64_tr_b16 v[178:179], v3 offset:25088
    s_waitcnt vmcnt(9) lgkmcnt(10)
    v_mfma_f32_32x32x16_bf16 v[128:143], v[196:199], v[88:91], v[128:143]
    ds_read_b64_tr_b16 v[188:189], v4 offset:26624
    ds_read_b64_tr_b16 v[190:191], v4 offset:27136
    s_waitcnt lgkmcnt(10)
    v_mfma_f32_32x32x16_bf16 v[112:127], v[192:195], v[88:91], v[112:127]
    ds_read_b64_tr_b16 v[184:185], v3 offset:26624
    ds_read_b64_tr_b16 v[186:187], v3 offset:27136
    s_waitcnt vmcnt(8) lgkmcnt(10)
    v_mfma_f32_32x32x16_bf16 v[128:143], v[204:207], v[92:95], v[128:143]
    s_add_u32 m0, s80, 69632
    s_add_u32 s84, s83, 114688
    ds_read_b64_tr_b16 v[196:197], v4 offset:28672
    ds_read_b64_tr_b16 v[198:199], v4 offset:29184
    s_waitcnt lgkmcnt(10)
    v_mfma_f32_32x32x16_bf16 v[112:127], v[200:203], v[92:95], v[112:127]
    buffer_load_dwordx4 v8, s[28:31], s84 offen  lds
    ds_read_b64_tr_b16 v[192:193], v3 offset:28672
    buffer_load_dwordx4 v0, s[28:31], s84 offen offset:1024  lds
    ds_read_b64_tr_b16 v[194:195], v3 offset:29184
    s_waitcnt vmcnt(9) lgkmcnt(10)
    v_mfma_f32_32x32x16_bf16 v[128:143], v[180:183], v[96:99], v[128:143]
    ds_read_b64_tr_b16 v[204:205], v4 offset:30720
    ds_read_b64_tr_b16 v[206:207], v4 offset:31232
    s_waitcnt lgkmcnt(10)
    v_mfma_f32_32x32x16_bf16 v[112:127], v[176:179], v[96:99], v[112:127]
    buffer_load_dword v249, v250, s[40:43], s86 offen sc1
    ds_read_b64_tr_b16 v[200:201], v3 offset:30720
    ds_read_b64_tr_b16 v[202:203], v3 offset:31232
    s_waitcnt vmcnt(9) lgkmcnt(10)
    v_mfma_f32_32x32x16_bf16 v[128:143], v[188:191], v[100:103], v[128:143]
    s_waitcnt vmcnt(8) lgkmcnt(6)
    v_mfma_f32_32x32x16_bf16 v[128:143], v[196:199], v[104:107], v[128:143]
    s_add_u32 m0, s80, 71680
    s_add_u32 s84, s83, 172032
    buffer_load_dwordx4 v8, s[28:31], s84 offen  lds
    buffer_load_dwordx4 v0, s[28:31], s84 offen offset:1024  lds
    s_waitcnt vmcnt(9) lgkmcnt(2)
    v_mfma_f32_32x32x16_bf16 v[128:143], v[204:207], v[108:111], v[128:143]
    v_mfma_f32_32x32x16_bf16 v[112:127], v[184:187], v[100:103], v[112:127]
    v_mfma_f32_32x32x16_bf16 v[112:127], v[192:195], v[104:107], v[112:127]
    s_waitcnt lgkmcnt(0)
    v_mfma_f32_32x32x16_bf16 v[112:127], v[200:203], v[108:111], v[112:127]
    s_nop 7
    ds_write_b128 v23, v[128:131] offset:0
    ds_write_b128 v23, v[132:135] offset:1024
    ds_write_b128 v23, v[136:139] offset:2048
    ds_write_b128 v23, v[140:143] offset:3072
    s_waitcnt lgkmcnt(0)
    s_barrier
    s_add_u32 m0, s80, 73728
    s_add_u32 s84, s83, 229376
    buffer_load_dwordx4 v8, s[28:31], s84 offen  lds
    buffer_load_dwordx4 v0, s[28:31], s84 offen offset:1024  lds
    ds_read_b128 v[128:131], v24 offset:0
    ds_read_b128 v[132:135], v24 offset:1024
    ds_read_b128 v[136:139], v24 offset:2048
    ds_read_b128 v[140:143], v24 offset:3072
    v_dot2c_f32_bf16 v112, s44, v32
    v_dot2c_f32_bf16 v113, s45, v32
    v_dot2c_f32_bf16 v114, s44, v33
    v_dot2c_f32_bf16 v115, s45, v33
    v_dot2c_f32_bf16 v116, s44, v34
    v_dot2c_f32_bf16 v117, s45, v34
    v_dot2c_f32_bf16 v118, s44, v35
    v_dot2c_f32_bf16 v119, s45, v35
    v_dot2c_f32_bf16 v120, s44, v36
    v_dot2c_f32_bf16 v121, s45, v36
    v_dot2c_f32_bf16 v122, s44, v37
    v_dot2c_f32_bf16 v123, s45, v37
    v_dot2c_f32_bf16 v124, s44, v38
    v_dot2c_f32_bf16 v125, s45, v38
    v_dot2c_f32_bf16 v126, s44, v39
    v_dot2c_f32_bf16 v127, s45, v39
    s_waitcnt lgkmcnt(3)
    v_pk_add_f32 v[112:113], v[112:113], v[128:129]
    v_pk_add_f32 v[114:115], v[114:115], v[130:131]
    s_waitcnt lgkmcnt(2)
    v_pk_add_f32 v[116:117], v[116:117], v[132:133]
    v_pk_add_f32 v[118:119], v[118:119], v[134:135]
    s_waitcnt lgkmcnt(1)
    v_pk_add_f32 v[120:121], v[120:121], v[136:137]
    v_pk_add_f32 v[122:123], v[122:123], v[138:139]
    s_add_u32 m0, s80, 75776
    s_add_u32 s84, s83, 286720
    buffer_load_dwordx4 v8, s[28:31], s84 offen  lds
    buffer_load_dwordx4 v0, s[28:31], s84 offen offset:1024  lds
    s_waitcnt lgkmcnt(0)
    v_pk_add_f32 v[124:125], v[124:125], v[140:141]
    v_pk_add_f32 v[126:127], v[126:127], v[142:143]
    v_cvt_pk_bf16_f32 v40, v112, v113
    v_cvt_pk_bf16_f32 v41, v114, v115
    v_cvt_pk_bf16_f32 v42, v116, v117
    v_cvt_pk_bf16_f32 v43, v118, v119
    v_cvt_pk_bf16_f32 v44, v120, v121
    v_cvt_pk_bf16_f32 v45, v122, v123
    v_cvt_pk_bf16_f32 v46, v124, v125
    v_cvt_pk_bf16_f32 v47, v126, v127
    buffer_store_dwordx4 v[40:43], v2, s[40:43], s89 offen sc1
    buffer_store_dwordx4 v[44:47], v2, s[40:43], s89 offen offset:1024 sc1
    v_dot2_f32_bf16 v208, v40, s65, 0
    v_dot2_f32_bf16 v209, v40, v40, 0
    v_dot2_f32_bf16 v210, v41, s65, 0
    v_dot2_f32_bf16 v211, v41, v41, 0
    v_dot2c_f32_bf16 v208, s65, v42
    v_dot2c_f32_bf16 v209, v42, v42
    v_dot2c_f32_bf16 v210, s65, v43
    v_dot2c_f32_bf16 v211, v43, v43
    v_dot2c_f32_bf16 v208, s65, v44
    v_dot2c_f32_bf16 v209, v44, v44
    v_dot2c_f32_bf16 v210, s65, v45
    v_dot2c_f32_bf16 v211, v45, v45
    v_dot2c_f32_bf16 v208, s65, v46
    v_dot2c_f32_bf16 v209, v46, v46
    v_dot2c_f32_bf16 v210, s65, v47
    v_dot2c_f32_bf16 v211, v47, v47
    s_nop 1
    v_add_f32 v208, v208, v210
    v_add_f32 v209, v209, v211
    v_mov_b32 v210, v208
    v_mov_b32 v211, v209
    s_nop 0
    v_permlane32_swap_b32 v208, v210
    v_permlane32_swap_b32 v209, v211
    v_add_f32 v208, v208, v210
    v_add_f32 v209, v209, v211
    s_mov_b64 exec, 0xffffffff
    buffer_store_dwordx2 v[208:209], v251, s[40:43], s85 offen sc1
    s_mov_b64 exec, -1
    s_lshl_b32 s67, s59, 6
    s_lshl_b32 s68, s58, 1
    s_add_u32 s67, s67, s68
    s_add_u32 s67, s67, s55
    s_lshl_b32 s67, s67, 12
    s_lshl_b32 s68, s56, 11
    s_add_u32 s67, s67, s68
    s_add_u32 s67, s67, 12582912
    s_mul_i32 s69, s55, 4928
    s_add_u32 s68, s68, s69
    s_mov_b32 s9, s67
    s_mov_b32 s10, s68
    s_mov_b32 s67, s9
    s_mov_b32 s68, s10
    s_add_u32 s87, s64, 1
    s_waitcnt vmcnt(9)
    v_subrev_u32 v249, s87, v249
    v_cmp_lt_u32 vcc, 5, v249
    s_cbranch_vccz L_pdone_4
    s_mov_b32 s71, 400000
L_poll_3:
    s_sleep 3
    s_sub_u32 s71, s71, 1
    buffer_load_dword v249, v250, s[40:43], s86 offen sc1
    s_waitcnt vmcnt(0)
    v_subrev_u32 v249, s87, v249
    v_cmp_lt_u32 vcc, 5, v249
    s_cbranch_vccz L_pdone_4
    s_cmp_lg_u32 s71, 0
    s_cbranch_scc1 L_poll_3
L_pdone_4:
    s_add_u32 m0, s80, 0
    s_add_u32 s84, s83, 128
    buffer_load_dwordx4 v8, s[28:31], s84 offen  lds
    buffer_load_dwordx4 v0, s[28:31], s84 offen offset:1024  lds
    s_add_u32 m0, s68, 148256
    s_nop 0
    buffer_load_dwordx4 v2, s[40:43], s67 offen sc1 lds
    buffer_load_dwordx4 v2, s[40:43], s67 offen offset:1024 sc1 lds
    v_and_b32 v21, 15, v1
    v_lshrrev_b32 v22, 4, v1
    v_lshlrev_b32 v22, 4, v22
    s_lshl_b32 s68, s56, 8
    s_add_u32 s69, s69, s68
    s_add_u32 s69, s69, 148704
    v_lshlrev_b32 v15, 5, v21
    v_sub_u32 v15, v22, v15
    v_add_u32 v15, s69, v15
    v_add_u32 v10, 1, v21
    v_and_b32 v10, 30, v10
    v_lshl_add_u32 v10, v10, 1, v22
    v_and_b32 v21, 1, v21
    v_xor_b32 v21, 1, v21
    v_mul_u32_u24 v21, 4288, v21
    s_mul_i32 s67, s55, 8576
    s_add_u32 s67, s67, s68
    s_add_u32 s67, s67, 131072
    v_add3_u32 v10, v10, v21, s67
    v_add_u32 v11, 1024, v10
    v_add_u32 v12, 2048, v10
    v_add_u32 v13, 3072, v10
    s_cmp_eq_u32 s56, 0
    s_cselect_b32 s67, 4096, 0
    v_add_u32 v14, s67, v10
    v_and_b32 v24, 7, v1
    v_bfe_u32 v25, v1, 3, 1
    v_lshlrev_b32 v24, 9, v24
    v_lshl_add_u32 v17, v25, 8, v24
    s_lshl_b32 s69, s61, 1
    s_add_u32 s69, s69, s56
    s_lshl_b32 s85, s69, 12
    s_lshl_b32 s68, s55, 7
    s_add_u32 s85, s85, s68
    s_mul_i32 s89, s69, 229376
    s_lshl_b32 s68, s60, 12
    s_add_u32 s89, s89, s68
    s_lshl_b32 s68, s55, 10
    s_add_u32 s89, s89, s68
    s_add_u32 s89, s89, 5242880
    s_add_u32 s89, s89, s88
    s_lshl_b32 s69, s61, 2
    s_add_u32 s69, s69, s54
    s_lshl_b32 s92, s69, 15
    s_add_u32 s92, s92, 3145728
    s_add_u32 s92, s92, s88
    s_lshl_b32 s93, s69, 12
    s_add_u32 s93, s93, 16777216
    s_add_u32 s93, s93, s88
    s_add_u32 s62, s54, s59
    s_and_b32 s62, s62, 3
    s_add_u32 s46, s62, 0
    s_and_b32 s46, s46, 3
    s_lshl_b32 s46, s46, 7
    s_add_u32 s47, s62, 1
    s_and_b32 s47, s47, 3
    s_lshl_b32 s47, s47, 7
    s_add_u32 s3, s62, 2
    s_and_b32 s3, s3, 3
    s_lshl_b32 s3, s3, 7
    s_add_u32 s95, s62, 3
    s_and_b32 s95, s95, 3
    s_lshl_b32 s95, s95, 7
    s_lshl_b32 s12, s46, 6
    s_add_u32 s12, s12, s92
    s_add_u32 s20, s12, 4096
    s_lshl_b32 s13, s47, 6
    s_add_u32 s13, s13, s92
    s_add_u32 s21, s13, 4096
    s_lshl_b32 s14, s3, 6
    s_add_u32 s14, s14, s92
    s_add_u32 s22, s14, 4096
    s_lshl_b32 s15, s95, 6
    s_add_u32 s15, s15, s92
    s_add_u32 s23, s15, 4096
    s_lshl_b32 s8, s94, 9
    s_lshr_b32 s68, s58, 4
    s_lshl_b32 s68, s68, 8
    s_add_u32 s8, s8, s68
    s_add_u32 s8, s8, 131072
    v_and_b32 v21, 3, v1
    s_add_u32 m0, s80, 2048
    s_add_u32 s84, s83, 57472
    buffer_load_dwordx4 v8, s[28:31], s84 offen  lds
    buffer_load_dwordx4 v0, s[28:31], s84 offen offset:1024  lds
    s_add_u32 m0, s80, 4096
    s_add_u32 s84, s83, 114816
    buffer_load_dwordx4 v8, s[28:31], s84 offen  lds
    buffer_load_dwordx4 v0, s[28:31], s84 offen offset:1024  lds
    s_add_u32 m0, s80, 6144
    s_add_u32 s84, s83, 172160
    buffer_load_dwordx4 v8, s[28:31], s84 offen  lds
    buffer_load_dwordx4 v0, s[28:31], s84 offen offset:1024  lds
    s_mul_i32 s68, s55, 3
    v_add_u32 v21, s68, v21
    v_add_u32 v22, 6, v21
    v_lshrrev_b32 v22, 3, v22
    v_add_u32 v21, v21, v22
    v_bfe_u32 v22, v1, 2, 1
    v_lshlrev_b32 v21, 9, v21
    v_lshl_add_u32 v252, v22, 7, v21
    s_lshr_b32 s69, s58, 3
    s_lshl_b32 s69, s69, 3
    s_lshl_b32 s68, s56, 2
    s_add_u32 s69, s69, s68
    s_bfe_u32 s68, s58, 0x20001
    s_add_u32 s69, s69, s68
    s_lshl_b32 s69, s69, 12
    s_and_b32 s68, s58, 1
    s_lshl_b32 s68, s68, 8
    s_add_u32 s90, s69, s68
    s_mul_i32 s69, s54, 14336
    s_mul_i32 s68, s58, 229376
    s_add_u32 s68, s68, s69
    s_add_u32 s91, s68, 5242880
    s_lshl_b32 s69, s56, 15
    s_sub_u32 s69, s80, s69
    v_add_u32 v3, s69, v3
    v_add_u32 v4, s69, v4
    v_lshrrev_b32 v21, 5, v1
    v_lshl_add_u32 v250, v21, 7, v250
    v_lshlrev_b32 v21, 10, v21
    v_bfe_u32 v22, v1, 2, 2
    v_lshl_add_u32 v21, v22, 7, v21
    v_bfe_u32 v22, v1, 4, 1
    v_lshl_add_u32 v21, v22, 5, v21
    v_and_b32 v22, 3, v1
    v_lshl_add_u32 v21, v22, 3, v21
    s_lshl_b32 s69, s57, 12
    s_lshl_b32 s68, s55, 6
    s_add_u32 s69, s69, s68
    s_add_u32 s69, s69, 131072
    v_add_u32 v9, s69, v21
    s_lshl_b32 s9, s94, 5
    s_add_u32 s9, s9, s58
    s_lshl_b32 s9, s9, 13
    s_lshl_b32 s68, s54, 11
    s_add_u32 s9, s9, s68
    s_add_u32 s9, s9, 14680064
    s_add_u32 s10, s68, 131072
    s_lshl_b32 s11, s58, 1
    s_add_u32 s11, s11, s55
    s_lshl_b32 s11, s11, 11
    s_add_u32 s11, s11, 17301504
    v_add_u32_e64 v18, s64, 2
    s_add_u32 m0, s80, 8192
    s_add_u32 s84, s83, 229504
    buffer_load_dwordx4 v8, s[28:31], s84 offen  lds
    buffer_load_dwordx4 v0, s[28:31], s84 offen offset:1024  lds
    s_waitcnt vmcnt(12)
    s_mov_b64 exec, 1
    buffer_store_dword v18, v255, s[40:43], s79 offen sc1
    s_mov_b64 exec, -1
    s_waitcnt vmcnt(9)
    s_barrier
    ds_read2_b32 v[176:177], v14 offset0:0 offset1:1
    s_lshl_b32 s84, s2, 2
    s_add_u32 s84, s84, s54
    s_mul_i32 s84, s84, 1792
    s_mov_b64 exec, 16383
    buffer_load_dword a255, v243, s[32:35], s84 offen
    s_mov_b64 exec, -1
    ds_read2_b32 v[178:179], v14 offset0:2 offset1:3
    ds_read_b128 v[208:211], v15 offset:4096
    ds_read2_b32 v[180:181], v10 offset0:0 offset1:1
    ds_read2_b32 v[182:183], v10 offset0:2 offset1:3
    ds_read_b128 v[76:79], v15 offset:0
    ds_read_b128 v[72:75], v15 offset:512
    ds_read_b128 v[68:71], v15 offset:1024
    ds_read_b128 v[64:67], v15 offset:1536
    ds_read_b128 v[60:63], v15 offset:2048
    s_lshr_b32 s84, s2, 3
    s_lshl_b32 s84, s84, 2
    s_add_u32 s84, s84, s54
    s_mul_i32 s84, s84, 14336
    v_lshlrev_b32 v212, 10, v1
    s_mov_b64 exec, 16383
    buffer_load_dword a255, v212, s[32:35], s84 offen offset:384
    s_mov_b64 exec, -1
    ds_read_b128 v[56:59], v15 offset:2560
    s_waitcnt lgkmcnt(8)
    v_mfma_f32_16x16x32_bf16 v[172:175], v[176:179], v[208:211], 0
    ds_read_b128 v[52:55], v15 offset:3072
    ds_read2_b32 v[196:197], v11 offset0:0 offset1:1
    ds_read2_b32 v[198:199], v11 offset0:2 offset1:3
    s_waitcnt lgkmcnt(8)
    v_mfma_f32_16x16x32_bf16 v[172:175], v[180:183], v[76:79], v[172:175]
    ds_read_b128 v[48:51], v15 offset:3584
    ds_read2_b32 v[200:201], v12 offset0:128 offset1:129
    ds_read2_b32 v[202:203], v12 offset0:130 offset1:131
    s_waitcnt lgkmcnt(10)
    v_mfma_f32_16x16x32_bf16 v[168:171], v[180:183], v[72:75], 0
    ds_read2_b32 v[184:185], v13 offset0:128 offset1:129
    ds_read2_b32 v[186:187], v13 offset0:130 offset1:131
    s_waitcnt lgkmcnt(11)
    v_mfma_f32_16x16x32_bf16 v[164:167], v[180:183], v[68:71], 0
    ds_read2_b32 v[188:189], v10 offset0:128 offset1:129
    ds_read2_b32 v[190:191], v10 offset0:130 offset1:131
    s_waitcnt lgkmcnt(12)
    v_mfma_f32_16x16x32_bf16 v[160:163], v[180:183], v[64:67], 0
    ds_read2_b32 v[192:193], v13 offset0:0 offset1:1
    ds_read2_b32 v[194:195], v13 offset0:2 offset1:3
    s_waitcnt lgkmcnt(13)
    v_mfma_f32_16x16x32_bf16 v[156:159], v[180:183], v[60:63], 0
    ds_read_b128 v[108:111], v15 offset:64
    s_waitcnt lgkmcnt(13)
    v_mfma_f32_16x16x32_bf16 v[152:155], v[180:183], v[56:59], 0
    s_waitcnt lgkmcnt(12)
    v_mfma_f32_16x16x32_bf16 v[148:151], v[180:183], v[52:55], 0
    s_waitcnt lgkmcnt(9)
    v_mfma_f32_16x16x32_bf16 v[144:147], v[180:183], v[48:51], 0
    s_waitcnt lgkmcnt(5)
    v_mfma_f32_16x16x32_bf16 v[172:175], v[184:187], v[48:51], v[172:175]
    ds_read2_b32 v[204:205], v11 offset0:128 offset1:129
    ds_read2_b32 v[206:207], v11 offset0:130 offset1:131
    s_add_u32 m0, s80, 77824
    s_add_u32 s84, s83, 344064
    buffer_load_dwordx4 v8, s[28:31], s84 offen  lds
    buffer_load_dwordx4 v0, s[28:31], s84 offen offset:1024  lds
    v_mfma_f32_16x16x32_bf16 v[168:171], v[184:187], v[208:211], v[168:171]
    ds_read_b128 v[104:107], v15 offset:576
    s_waitcnt lgkmcnt(6)
    v_mfma_f32_16x16x32_bf16 v[172:175], v[188:191], v[72:75], v[172:175]
    ds_read2_b32 v[176:177], v12 offset0:0 offset1:1
    ds_read2_b32 v[178:179], v12 offset0:2 offset1:3
    v_mfma_f32_16x16x32_bf16 v[168:171], v[188:191], v[68:71], v[168:171]
    v_mfma_f32_16x16x32_bf16 v[164:167], v[188:191], v[64:67], v[164:167]
    v_mfma_f32_16x16x32_bf16 v[160:163], v[188:191], v[60:63], v[160:163]
    v_mfma_f32_16x16x32_bf16 v[156:159], v[188:191], v[56:59], v[156:159]
    ds_read_b128 v[100:103], v15 offset:1088
    v_mfma_f32_16x16x32_bf16 v[152:155], v[188:191], v[52:55], v[152:155]
    v_mfma_f32_16x16x32_bf16 v[148:151], v[188:191], v[48:51], v[148:151]
    v_mfma_f32_16x16x32_bf16 v[144:147], v[188:191], v[208:211], v[144:147]
    s_waitcnt lgkmcnt(7)
    v_mfma_f32_16x16x32_bf16 v[172:175], v[192:195], v[52:55], v[172:175]
    ds_read2_b32 v[180:181], v10 offset0:16 offset1:17
    ds_read2_b32 v[182:183], v10 offset0:18 offset1:19
    v_mfma_f32_16x16x32_bf16 v[168:171], v[192:195], v[48:51], v[168:171]
    ds_read_b128 v[96:99], v15 offset:1600
    v_mfma_f32_16x16x32_bf16 v[164:167], v[192:195], v[208:211], v[164:167]
    v_mfma_f32_16x16x32_bf16 v[172:175], v[196:199], v[68:71], v[172:175]
    s_add_u32 m0, s80, 79872
    s_add_u32 s84, s83, 401408
    ds_read2_b32 v[184:185], v13 offset0:144 offset1:145
    buffer_load_dwordx4 v8, s[28:31], s84 offen  lds
    ds_read2_b32 v[186:187], v13 offset0:146 offset1:147
    buffer_load_dwordx4 v0, s[28:31], s84 offen offset:1024  lds
    v_mfma_f32_16x16x32_bf16 v[168:171], v[196:199], v[64:67], v[168:171]
    v_mfma_f32_16x16x32_bf16 v[164:167], v[196:199], v[60:63], v[164:167]
    v_mfma_f32_16x16x32_bf16 v[160:163], v[196:199], v[56:59], v[160:163]
    ds_read_b128 v[92:95], v15 offset:2112
    v_mfma_f32_16x16x32_bf16 v[156:159], v[196:199], v[52:55], v[156:159]
    v_mfma_f32_16x16x32_bf16 v[152:155], v[196:199], v[48:51], v[152:155]
    v_mfma_f32_16x16x32_bf16 v[148:151], v[196:199], v[208:211], v[148:151]
    v_mfma_f32_16x16x32_bf16 v[172:175], v[200:203], v[56:59], v[172:175]
    ds_read2_b32 v[188:189], v10 offset0:144 offset1:145
    ds_read2_b32 v[190:191], v10 offset0:146 offset1:147
    v_mfma_f32_16x16x32_bf16 v[168:171], v[200:203], v[52:55], v[168:171]
    v_mfma_f32_16x16x32_bf16 v[164:167], v[200:203], v[48:51], v[164:167]
    ds_read_b128 v[88:91], v15 offset:2624
    v_mfma_f32_16x16x32_bf16 v[160:163], v[200:203], v[208:211], v[160:163]
    s_waitcnt lgkmcnt(13)
    v_mfma_f32_16x16x32_bf16 v[172:175], v[204:207], v[64:67], v[172:175]
    ds_read2_b32 v[192:193], v13 offset0:16 offset1:17
    ds_read2_b32 v[194:195], v13 offset0:18 offset1:19
    v_mfma_f32_16x16x32_bf16 v[168:171], v[204:207], v[60:63], v[168:171]
    v_mfma_f32_16x16x32_bf16 v[164:167], v[204:207], v[56:59], v[164:167]
    s_add_u32 m0, s80, 10240
    s_add_u32 s84, s83, 286848
    v_mfma_f32_16x16x32_bf16 v[160:163], v[204:207], v[52:55], v[160:163]
    buffer_load_dwordx4 v8, s[28:31], s84 offen  lds
    ds_read_b128 v[84:87], v15 offset:3136
    buffer_load_dwordx4 v0, s[28:31], s84 offen offset:1024  lds
    v_mfma_f32_16x16x32_bf16 v[156:159], v[204:207], v[48:51], v[156:159]
    v_mfma_f32_16x16x32_bf16 v[152:155], v[204:207], v[208:211], v[152:155]
    s_waitcnt lgkmcnt(13)
    v_mfma_f32_16x16x32_bf16 v[172:175], v[176:179], v[60:63], v[172:175]
    ds_read2_b32 v[196:197], v11 offset0:16 offset1:17
    ds_read2_b32 v[198:199], v11 offset0:18 offset1:19
    v_mfma_f32_16x16x32_bf16 v[168:171], v[176:179], v[56:59], v[168:171]
    v_mfma_f32_16x16x32_bf16 v[164:167], v[176:179], v[52:55], v[164:167]
    ds_read_b128 v[80:83], v15 offset:3648
    v_mfma_f32_16x16x32_bf16 v[160:163], v[176:179], v[48:51], v[160:163]
    v_mfma_f32_16x16x32_bf16 v[156:159], v[176:179], v[208:211], v[156:159]
    s_waitcnt lgkmcnt(13)
    v_mfma_f32_16x16x32_bf16 v[172:175], v[180:183], v[108:111], v[172:175]
    ds_read2_b32 v[200:201], v12 offset0:144 offset1:145
    ds_read2_b32 v[202:203], v12 offset0:146 offset1:147
    v_mfma_f32_16x16x32_bf16 v[168:171], v[180:183], v[104:107], v[168:171]
    v_mfma_f32_16x16x32_bf16 v[164:167], v[180:183], v[100:103], v[164:167]
    s_waitcnt lgkmcnt(14)
    v_mfma_f32_16x16x32_bf16 v[160:163], v[180:183], v[96:99], v[160:163]
    s_waitcnt lgkmcnt(11)
    v_mfma_f32_16x16x32_bf16 v[156:159], v[180:183], v[92:95], v[156:159]
    s_add_u32 m0, s80, 12288
    s_add_u32 s84, s83, 344192
    ds_read_b128 v[76:79], v15 offset:128
    buffer_load_dwordx4 v8, s[28:31], s84 offen  lds
    s_waitcnt lgkmcnt(9)
    v_mfma_f32_16x16x32_bf16 v[152:155], v[180:183], v[88:91], v[152:155]
    buffer_load_dwordx4 v0, s[28:31], s84 offen offset:1024  lds
    s_waitcnt lgkmcnt(6)
    v_mfma_f32_16x16x32_bf16 v[148:151], v[180:183], v[84:87], v[148:151]
    s_waitcnt lgkmcnt(3)
    v_mfma_f32_16x16x32_bf16 v[144:147], v[180:183], v[80:83], v[144:147]
    v_mfma_f32_16x16x32_bf16 v[172:175], v[184:187], v[80:83], v[172:175]
    ds_read2_b32 v[204:205], v11 offset0:144 offset1:145
    ds_read2_b32 v[206:207], v11 offset0:146 offset1:147
    ds_read_b128 v[72:75], v15 offset:640
    v_mfma_f32_16x16x32_bf16 v[172:175], v[188:191], v[104:107], v[172:175]
    ds_read2_b32 v[176:177], v12 offset0:16 offset1:17
    ds_read2_b32 v[178:179], v12 offset0:18 offset1:19
    v_mfma_f32_16x16x32_bf16 v[168:171], v[188:191], v[100:103], v[168:171]
    v_mfma_f32_16x16x32_bf16 v[164:167], v[188:191], v[96:99], v[164:167]
    v_mfma_f32_16x16x32_bf16 v[160:163], v[188:191], v[92:95], v[160:163]
    ds_read_b128 v[68:71], v15 offset:1152
    v_mfma_f32_16x16x32_bf16 v[156:159], v[188:191], v[88:91], v[156:159]
    v_mfma_f32_16x16x32_bf16 v[152:155], v[188:191], v[84:87], v[152:155]
    v_mfma_f32_16x16x32_bf16 v[148:151], v[188:191], v[80:83], v[148:151]
    v_mfma_f32_16x16x32_bf16 v[172:175], v[192:195], v[84:87], v[172:175]
    ds_read2_b32 v[180:181], v10 offset0:32 offset1:33
    ds_read2_b32 v[182:183], v10 offset0:34 offset1:35
    v_mfma_f32_16x16x32_bf16 v[168:171], v[192:195], v[80:83], v[168:171]
    ds_read_b128 v[64:67], v15 offset:1664
    v_mfma_f32_16x16x32_bf16 v[172:175], v[196:199], v[100:103], v[172:175]
    ds_read2_b32 v[184:185], v13 offset0:160 offset1:161
    ds_read2_b32 v[186:187], v13 offset0:162 offset1:163
    v_mfma_f32_16x16x32_bf16 v[168:171], v[196:199], v[96:99], v[168:171]
    v_mfma_f32_16x16x32_bf16 v[164:167], v[196:199], v[92:95], v[164:167]
    v_mfma_f32_16x16x32_bf16 v[160:163], v[196:199], v[88:91], v[160:163]
    ds_read_b128 v[60:63], v15 offset:2176
    v_mfma_f32_16x16x32_bf16 v[156:159], v[196:199], v[84:87], v[156:159]
    v_mfma_f32_16x16x32_bf16 v[152:155], v[196:199], v[80:83], v[152:155]
    s_waitcnt lgkmcnt(13)
    v_mfma_f32_16x16x32_bf16 v[172:175], v[200:203], v[88:91], v[172:175]
    ds_read2_b32 v[188:189], v10 offset0:160 offset1:161
    ds_read2_b32 v[190:191], v10 offset0:162 offset1:163
    v_mfma_f32_16x16x32_bf16 v[168:171], v[200:203], v[84:87], v[168:171]
    ds_read_b128 v[56:59], v15 offset:2688
    v_mfma_f32_16x16x32_bf16 v[164:167], v[200:203], v[80:83], v[164:167]
    s_waitcnt lgkmcnt(13)
    v_mfma_f32_16x16x32_bf16 v[172:175], v[204:207], v[96:99], v[172:175]
    ds_read2_b32 v[192:193], v13 offset0:32 offset1:33
    ds_read2_b32 v[194:195], v13 offset0:34 offset1:35
    v_mfma_f32_16x16x32_bf16 v[168:171], v[204:207], v[92:95], v[168:171]
    s_add_u32 m0, s80, 14336
    s_add_u32 s84, s83, 401536
    v_mfma_f32_16x16x32_bf16 v[164:167], v[204:207], v[88:91], v[164:167]
    buffer_load_dwordx4 v8, s[28:31], s84 offen  lds
    ds_read_b128 v[52:55], v15 offset:3200
    buffer_load_dwordx4 v0, s[28:31], s84 offen offset:1024  lds
    v_mfma_f32_16x16x32_bf16 v[160:163], v[204:207], v[84:87], v[160:163]
    v_mfma_f32_16x16x32_bf16 v[156:159], v[204:207], v[80:83], v[156:159]
    s_waitcnt lgkmcnt(13)
    v_mfma_f32_16x16x32_bf16 v[172:175], v[176:179], v[92:95], v[172:175]
    ds_read2_b32 v[196:197], v11 offset0:32 offset1:33
    ds_read2_b32 v[198:199], v11 offset0:34 offset1:35
    v_mfma_f32_16x16x32_bf16 v[168:171], v[176:179], v[88:91], v[168:171]
    v_mfma_f32_16x16x32_bf16 v[164:167], v[176:179], v[84:87], v[164:167]
    ds_read_b128 v[48:51], v15 offset:3712
    v_mfma_f32_16x16x32_bf16 v[160:163], v[176:179], v[80:83], v[160:163]
    buffer_load_dword v248, v17, s[40:43], s85 offen sc1
    s_waitcnt lgkmcnt(13)
    v_mfma_f32_16x16x32_bf16 v[172:175], v[180:183], v[76:79], v[172:175]
    ds_read2_b32 v[200:201], v12 offset0:160 offset1:161
    ds_read2_b32 v[202:203], v12 offset0:162 offset1:163
    v_mfma_f32_16x16x32_bf16 v[168:171], v[180:183], v[72:75], v[168:171]
    v_mfma_f32_16x16x32_bf16 v[164:167], v[180:183], v[68:71], v[164:167]
    s_waitcnt lgkmcnt(14)
    v_mfma_f32_16x16x32_bf16 v[160:163], v[180:183], v[64:67], v[160:163]
    s_waitcnt lgkmcnt(11)
    v_mfma_f32_16x16x32_bf16 v[156:159], v[180:183], v[60:63], v[156:159]
    ds_read_b128 v[108:111], v15 offset:192
    s_waitcnt lgkmcnt(9)
    v_mfma_f32_16x16x32_bf16 v[152:155], v[180:183], v[56:59], v[152:155]
    s_waitcnt lgkmcnt(6)
    v_mfma_f32_16x16x32_bf16 v[148:151], v[180:183], v[52:55], v[148:151]
    s_waitcnt lgkmcnt(3)
    v_mfma_f32_16x16x32_bf16 v[144:147], v[180:183], v[48:51], v[144:147]
    v_mfma_f32_16x16x32_bf16 v[172:175], v[184:187], v[48:51], v[172:175]
    ds_read2_b32 v[204:205], v11 offset0:160 offset1:161
    ds_read2_b32 v[206:207], v11 offset0:162 offset1:163
    ds_read_b128 v[104:107], v15 offset:704
    v_mfma_f32_16x16x32_bf16 v[172:175], v[188:191], v[72:75], v[172:175]
    ds_read2_b32 v[176:177], v12 offset0:32 offset1:33
    ds_read2_b32 v[178:179], v12 offset0:34 offset1:35
    v_mfma_f32_16x16x32_bf16 v[168:171], v[188:191], v[68:71], v[168:171]
    v_mfma_f32_16x16x32_bf16 v[164:167], v[188:191], v[64:67], v[164:167]
    v_mfma_f32_16x16x32_bf16 v[160:163], v[188:191], v[60:63], v[160:163]
    ds_read_b128 v[100:103], v15 offset:1216
    v_mfma_f32_16x16x32_bf16 v[156:159], v[188:191], v[56:59], v[156:159]
    v_mfma_f32_16x16x32_bf16 v[152:155], v[188:191], v[52:55], v[152:155]
    v_mfma_f32_16x16x32_bf16 v[148:151], v[188:191], v[48:51], v[148:151]
    s_add_u32 s84, s72, 32768
    buffer_load_dwordx4 a[128:131], v7, s[32:35], s84 offen
    v_mfma_f32_16x16x32_bf16 v[172:175], v[192:195], v[52:55], v[172:175]
    buffer_load_dwordx4 a[132:135], v6, s[32:35], s84 offen offset:1024
    ds_read2_b32 v[180:181], v10 offset0:48 offset1:49
    ds_read2_b32 v[182:183], v10 offset0:50 offset1:51
    v_mfma_f32_16x16x32_bf16 v[168:171], v[192:195], v[48:51], v[168:171]
    ds_read_b128 v[96:99], v15 offset:1728
    v_mfma_f32_16x16x32_bf16 v[172:175], v[196:199], v[68:71], v[172:175]
    ds_read2_b32 v[184:185], v13 offset0:176 offset1:177
    ds_read2_b32 v[186:187], v13 offset0:178 offset1:179
    v_mfma_f32_16x16x32_bf16 v[168:171], v[196:199], v[64:67], v[168:171]
    v_mfma_f32_16x16x32_bf16 v[164:167], v[196:199], v[60:63], v[164:167]
    v_mfma_f32_16x16x32_bf16 v[160:163], v[196:199], v[56:59], v[160:163]
    ds_read_b128 v[92:95], v15 offset:2240
    v_mfma_f32_16x16x32_bf16 v[156:159], v[196:199], v[52:55], v[156:159]
    v_mfma_f32_16x16x32_bf16 v[152:155], v[196:199], v[48:51], v[152:155]
    s_waitcnt lgkmcnt(13)
    v_mfma_f32_16x16x32_bf16 v[172:175], v[200:203], v[56:59], v[172:175]
    ds_read2_b32 v[188:189], v10 offset0:176 offset1:177
    ds_read2_b32 v[190:191], v10 offset0:178 offset1:179
    v_mfma_f32_16x16x32_bf16 v[168:171], v[200:203], v[52:55], v[168:171]
    ds_read_b128 v[88:91], v15 offset:2752
    v_mfma_f32_16x16x32_bf16 v[164:167], v[200:203], v[48:51], v[164:167]
    s_lshl_b32 s67, s54, 12
    s_add_u32 s67, s67, 131072
    v_add_u32 v24, s67, v2
    s_waitcnt lgkmcnt(13)
    v_mfma_f32_16x16x32_bf16 v[172:175], v[204:207], v[64:67], v[172:175]
    ds_read2_b32 v[192:193], v13 offset0:48 offset1:49
    ds_read2_b32 v[194:195], v13 offset0:50 offset1:51
    s_add_u32 s84, s73, 32768
    buffer_load_dwordx4 a[136:139], v7, s[32:35], s84 offen
    buffer_load_dwordx4 a[140:143], v6, s[32:35], s84 offen offset:1024
    v_mfma_f32_16x16x32_bf16 v[168:171], v[204:207], v[60:63], v[168:171]
    v_xor_b32 v21, 8192, v24
    v_mfma_f32_16x16x32_bf16 v[164:167], v[204:207], v[56:59], v[164:167]
    ds_read_b128 v[84:87], v15 offset:3264
    v_mfma_f32_16x16x32_bf16 v[160:163], v[204:207], v[52:55], v[160:163]
    v_and_b32 v22, 15, v1
    v_mfma_f32_16x16x32_bf16 v[156:159], v[204:207], v[48:51], v[156:159]
    v_lshlrev_b32 v22, 5, v22
    s_waitcnt lgkmcnt(13)
    v_mfma_f32_16x16x32_bf16 v[172:175], v[176:179], v[60:63], v[172:175]
    ds_read2_b32 v[196:197], v11 offset0:48 offset1:49
    ds_read2_b32 v[198:199], v11 offset0:50 offset1:51
    v_mfma_f32_16x16x32_bf16 v[168:171], v[176:179], v[56:59], v[168:171]
    v_lshrrev_b32 v23, 4, v1
    v_mfma_f32_16x16x32_bf16 v[164:167], v[176:179], v[52:55], v[164:167]
    v_lshl_add_u32 v22, v23, 3, v22
    ds_read_b128 v[80:83], v15 offset:3776
    v_mfma_f32_16x16x32_bf16 v[160:163], v[176:179], v[48:51], v[160:163]
    s_waitcnt vmcnt(7)
    s_add_u32 s84, s74, 32768
    buffer_load_dwordx4 a[144:147], v7, s[32:35], s84 offen
    buffer_load_dwordx4 a[148:151], v6, s[32:35], s84 offen offset:1024
    s_add_u32 s87, s64, 2
    s_waitcnt vmcnt(6)
    v_subrev_u32 v248, s87, v248
    v_cmp_lt_u32 vcc, 4, v248
    s_cbranch_vccz L_pdone_6
    s_mov_b32 s71, 400000
L_poll_5:
    s_sleep 3
    s_sub_u32 s71, s71, 1
    buffer_load_dword v248, v17, s[40:43], s85 offen sc1
    s_waitcnt vmcnt(0)
    v_subrev_u32 v248, s87, v248
    v_cmp_lt_u32 vcc, 4, v248
    s_cbranch_vccz L_pdone_6
    s_cmp_lg_u32 s71, 0
    s_cbranch_scc1 L_poll_5
L_pdone_6:
    s_add_u32 s84, s75, 32768
    buffer_load_dwordx4 a[152:155], v7, s[32:35], s84 offen
    buffer_load_dwordx4 a[156:159], v6, s[32:35], s84 offen offset:1024
    s_waitcnt lgkmcnt(13)
    v_mfma_f32_16x16x32_bf16 v[172:175], v[180:183], v[108:111], v[172:175]
    buffer_load_dwordx4 a[0:3], v2, s[40:43], s12 offen offset:0 sc1
    ds_read2_b32 v[200:201], v12 offset0:176 offset1:177
    buffer_load_dwordx4 a[4:7], v2, s[40:43], s12 offen offset:1024 sc1
    ds_read2_b32 v[202:203], v12 offset0:178 offset1:179
    v_mfma_f32_16x16x32_bf16 v[168:171], v[180:183], v[104:107], v[168:171]
    v_mfma_f32_16x16x32_bf16 v[164:167], v[180:183], v[100:103], v[164:167]
    s_waitcnt lgkmcnt(14)
    v_mfma_f32_16x16x32_bf16 v[160:163], v[180:183], v[96:99], v[160:163]
    s_mul_i32 s68, s55, 4928
    s_add_u32 s68, s68, 150808
    s_lshl_b32 s69, s56, 11
    s_sub_u32 s68, s68, s69
    v_sub_u32 v23, s68, v22
    s_waitcnt lgkmcnt(11)
    v_mfma_f32_16x16x32_bf16 v[156:159], v[180:183], v[92:95], v[156:159]
    s_waitcnt lgkmcnt(8)
    v_mfma_f32_16x16x32_bf16 v[152:155], v[180:183], v[88:91], v[152:155]
    s_waitcnt lgkmcnt(5)
    v_mfma_f32_16x16x32_bf16 v[148:151], v[180:183], v[84:87], v[148:151]
    s_xor_b32 s67, s67, 8192
    v_add_u32 v22, s67, v22
    s_waitcnt lgkmcnt(2)
    v_mfma_f32_16x16x32_bf16 v[144:147], v[180:183], v[80:83], v[144:147]
    v_lshlrev_b32 v237, 16, v237
    v_mfma_f32_16x16x32_bf16 v[172:175], v[184:187], v[80:83], v[172:175]
    buffer_load_dwordx4 a[8:11], v2, s[40:43], s12 offen offset:2048 sc1
    ds_read2_b32 v[204:205], v11 offset0:176 offset1:177
    buffer_load_dwordx4 a[12:15], v2, s[40:43], s12 offen offset:3072 sc1
    ds_read2_b32 v[206:207], v11 offset0:178 offset1:179
    v_mfma_f32_16x16x32_bf16 v[172:175], v[188:191], v[104:107], v[172:175]
    ds_read2_b32 v[176:177], v12 offset0:48 offset1:49
    ds_read2_b32 v[178:179], v12 offset0:50 offset1:51
    v_mfma_f32_16x16x32_bf16 v[168:171], v[188:191], v[100:103], v[168:171]
    v_mfma_f32_16x16x32_bf16 v[164:167], v[188:191], v[96:99], v[164:167]
    v_and_b32 v25, 8, v1
    v_mfma_f32_16x16x32_bf16 v[160:163], v[188:191], v[92:95], v[160:163]
    v_mfma_f32_16x16x32_bf16 v[156:159], v[188:191], v[88:91], v[156:159]
    v_cmp_eq_u32 vcc, 0, v25
    v_mfma_f32_16x16x32_bf16 v[152:155], v[188:191], v[84:87], v[152:155]
    s_nop 0
    v_cndmask_b32 v232, v244, v19, vcc
    v_mfma_f32_16x16x32_bf16 v[148:151], v[188:191], v[80:83], v[148:151]
    v_mfma_f32_16x16x32_bf16 v[172:175], v[192:195], v[84:87], v[172:175]
    v_cndmask_b32 v233, v245, v19, vcc
    v_mfma_f32_16x16x32_bf16 v[168:171], v[192:195], v[80:83], v[168:171]
    v_cndmask_b32 v234, v246, v19, vcc
    v_mfma_f32_16x16x32_bf16 v[172:175], v[196:199], v[100:103], v[172:175]
    v_cndmask_b32 v235, v247, v19, vcc
    v_mfma_f32_16x16x32_bf16 v[168:171], v[196:199], v[96:99], v[168:171]
    v_mfma_f32_16x16x32_bf16 v[164:167], v[196:199], v[92:95], v[164:167]
    v_cndmask_b32 v244, v19, v244, vcc
    v_mfma_f32_16x16x32_bf16 v[160:163], v[196:199], v[88:91], v[160:163]
    buffer_load_dwordx4 a[16:19], v2, s[40:43], s20 offen offset:0 sc1
    v_cndmask_b32 v245, v19, v245, vcc
    buffer_load_dwordx4 a[20:23], v2, s[40:43], s20 offen offset:1024 sc1
    v_mfma_f32_16x16x32_bf16 v[156:159], v[196:199], v[84:87], v[156:159]
    v_mfma_f32_16x16x32_bf16 v[152:155], v[196:199], v[80:83], v[152:155]
    v_cndmask_b32 v246, v19, v246, vcc
    s_waitcnt lgkmcnt(4)
    v_mfma_f32_16x16x32_bf16 v[172:175], v[200:203], v[88:91], v[172:175]
    v_cndmask_b32 v247, v19, v247, vcc
    v_mfma_f32_16x16x32_bf16 v[168:171], v[200:203], v[84:87], v[168:171]
    v_mfma_f32_16x16x32_bf16 v[164:167], v[200:203], v[80:83], v[164:167]
    v_lshlrev_b32 v26, 2, v1
    s_waitcnt lgkmcnt(2)
    v_mfma_f32_16x16x32_bf16 v[172:175], v[204:207], v[96:99], v[172:175]
    v_add_u32 v26, 159744, v26
    v_mfma_f32_16x16x32_bf16 v[168:171], v[204:207], v[92:95], v[168:171]
    v_mfma_f32_16x16x32_bf16 v[164:167], v[204:207], v[88:91], v[164:167]
    s_lshl_b32 s67, s54, 8
    v_add_u32 v253, s67, v26
    v_mfma_f32_16x16x32_bf16 v[160:163], v[204:207], v[84:87], v[160:163]
    v_mfma_f32_16x16x32_bf16 v[156:159], v[204:207], v[80:83], v[156:159]
    s_waitcnt lgkmcnt(0)
    v_mfma_f32_16x16x32_bf16 v[172:175], v[176:179], v[92:95], v[172:175]
    s_add_u32 s67, s67, 162816
    v_add_u32 v20, s67, v20
    v_mfma_f32_16x16x32_bf16 v[168:171], v[176:179], v[88:91], v[168:171]
    v_mfma_f32_16x16x32_bf16 v[164:167], v[176:179], v[84:87], v[164:167]
    v_mfma_f32_16x16x32_bf16 v[160:163], v[176:179], v[80:83], v[160:163]
    buffer_load_dwordx4 a[24:27], v2, s[40:43], s20 offen offset:2048 sc1
    buffer_load_dwordx4 a[28:31], v2, s[40:43], s20 offen offset:3072 sc1
    s_barrier
    s_lshl_b32 s67, s46, 7
    s_add_u32 s67, s67, 65536
    v_add_u32 v13, s67, v5
    v_xor_b32 v14, 64, v13
    ds_read_b64_tr_b16 v[176:177], v13 offset:0
    ds_read_b64_tr_b16 v[178:179], v13 offset:512
    ds_read_b64_tr_b16 v[180:181], v14 offset:0
    ds_read_b64_tr_b16 v[182:183], v14 offset:512
    ds_read_b64_tr_b16 v[184:185], v13 offset:2048
    ds_read_b64_tr_b16 v[186:187], v13 offset:2560
    ds_read_b64_tr_b16 v[188:189], v14 offset:2048
    ds_read_b64_tr_b16 v[190:191], v14 offset:2560
    ds_read_b64_tr_b16 v[192:193], v13 offset:4096
    ds_read_b64_tr_b16 v[194:195], v13 offset:4608
    ds_read_b64_tr_b16 v[196:197], v14 offset:4096
    ds_read_b64_tr_b16 v[198:199], v14 offset:4608
    s_lshl_b32 s67, s47, 7
    s_add_u32 s67, s67, 65536
    v_add_u32 v15, s67, v5
    v_xor_b32 v16, 64, v15
    s_cmp_lg_u32 s56, 0
    s_cbranch_scc1 L_convhi_7
    ds_write_b128 v24, v[160:163] offset:0
    ds_write_b128 v24, v[164:167] offset:1024
    ds_write_b128 v24, v[168:171] offset:2048
    ds_write_b128 v24, v[172:175] offset:3072
    s_waitcnt lgkmcnt(0)
    s_barrier
    ds_read_b128 v[160:163], v21 offset:0
    ds_read_b128 v[164:167], v21 offset:1024
    ds_read_b128 v[168:171], v21 offset:2048
    ds_read_b128 v[172:175], v21 offset:3072
    s_branch L_convjoin_8
L_convhi_7:
    ds_write_b128 v24, v[144:147] offset:0
    ds_write_b128 v24, v[148:151] offset:1024
    ds_write_b128 v24, v[152:155] offset:2048
    ds_write_b128 v24, v[156:159] offset:3072
    s_waitcnt lgkmcnt(0)
    s_barrier
    ds_read_b128 v[144:147], v21 offset:0
    ds_read_b128 v[148:151], v21 offset:1024
    ds_read_b128 v[152:155], v21 offset:2048
    ds_read_b128 v[156:159], v21 offset:3072
L_convjoin_8:
    buffer_load_dwordx4 a[32:35], v2, s[40:43], s13 offen offset:0 sc1
    buffer_load_dwordx4 a[36:39], v2, s[40:43], s13 offen offset:1024 sc1
    s_waitcnt lgkmcnt(15) vmcnt(9)
    v_mfma_f32_32x32x16_bf16 v[112:127], v[176:179], a[0:3], 0
    buffer_load_dwordx2 v[48:49], v251, s[40:43], s93 offen offset:0 sc1
    ds_read_b64_tr_b16 v[200:201], v13 offset:6144
    buffer_load_dwordx2 v[50:51], v251, s[40:43], s93 offen offset:512 sc1
    ds_read_b64_tr_b16 v[202:203], v13 offset:6656
    v_mfma_f32_32x32x16_bf16 v[128:143], v[180:183], a[0:3], 0
    ds_read_b64 v[64:65], v23 offset:1536
    ds_read_b64 v[66:67], v23 offset:1024
    ds_read_b64 v[68:69], v23 offset:512
    ds_read_b64_tr_b16 v[204:205], v14 offset:6144
    ds_read_b64_tr_b16 v[206:207], v14 offset:6656
    v_mfma_f32_16x16x32_bf16 v[208:211], v[244:247], v[176:179], 0
    buffer_load_dwordx2 v[52:53], v251, s[40:43], s93 offen offset:1024 sc1
    ds_read_b64 v[70:71], v23 offset:0
    buffer_load_dwordx2 v[54:55], v251, s[40:43], s93 offen offset:1536 sc1
    v_mfma_f32_16x16x32_bf16 v[208:211], v[232:235], v[180:183], v[208:211]
    buffer_load_dwordx2 v[56:57], v251, s[40:43], s93 offen offset:2048 sc1
    s_waitcnt lgkmcnt(15) vmcnt(13)
    v_mfma_f32_32x32x16_bf16 v[112:127], v[184:187], a[4:7], v[112:127]
    buffer_load_dwordx2 v[58:59], v251, s[40:43], s93 offen offset:2560 sc1
    s_waitcnt lgkmcnt(8)
    v_add_f32 v144, v144, v160
    buffer_load_dwordx2 v[60:61], v251, s[40:43], s93 offen offset:3072 sc1
    buffer_load_dwordx2 v[62:63], v251, s[40:43], s93 offen offset:3584 sc1
    v_add_f32 v145, v145, v161
    ds_read_b64_tr_b16 v[176:177], v13 offset:8192
    ds_read_b64_tr_b16 v[178:179], v13 offset:8704
    v_mfma_f32_32x32x16_bf16 v[128:143], v[188:191], a[4:7], v[128:143]
    v_add_f32 v146, v146, v162
    v_add_f32 v147, v147, v163
    v_add_f32 v148, v148, v164
    ds_read_b64_tr_b16 v[180:181], v14 offset:8192
    ds_read_b64_tr_b16 v[182:183], v14 offset:8704
    v_mfma_f32_16x16x32_bf16 v[208:211], v[244:247], v[184:187], v[208:211]
    v_add_f32 v149, v149, v165
    v_mfma_f32_16x16x32_bf16 v[208:211], v[232:235], v[188:191], v[208:211]
    s_waitcnt vmcnt(15)
    v_mfma_f32_32x32x16_bf16 v[112:127], v[192:195], a[8:11], v[112:127]
    v_add_f32 v150, v150, v166
    v_add_f32 v151, v151, v167
    v_add_f32 v152, v152, v168
    ds_read_b64_tr_b16 v[184:185], v13 offset:10240
    ds_read_b64_tr_b16 v[186:187], v13 offset:10752
    v_mfma_f32_32x32x16_bf16 v[128:143], v[196:199], a[8:11], v[128:143]
    v_add_f32 v153, v153, v169
    v_add_f32 v154, v154, v170
    v_add_f32 v155, v155, v171
    ds_read_b64_tr_b16 v[188:189], v14 offset:10240
    ds_read_b64_tr_b16 v[190:191], v14 offset:10752
    v_mfma_f32_16x16x32_bf16 v[208:211], v[244:247], v[192:195], v[208:211]
    buffer_load_dwordx4 a[40:43], v2, s[40:43], s13 offen offset:2048 sc1
    v_add_f32 v156, v156, v172
    buffer_load_dwordx4 a[44:47], v2, s[40:43], s13 offen offset:3072 sc1
    v_mfma_f32_16x16x32_bf16 v[208:211], v[232:235], v[196:199], v[208:211]
    s_waitcnt lgkmcnt(9) vmcnt(16)
    v_mfma_f32_32x32x16_bf16 v[112:127], v[200:203], a[12:15], v[112:127]
    v_add_f32 v157, v157, v173
    v_add_f32 v158, v158, v174
    v_add_f32 v159, v159, v175
    ds_read_b64_tr_b16 v[192:193], v13 offset:12288
    ds_read_b64_tr_b16 v[194:195], v13 offset:12800
    v_mfma_f32_32x32x16_bf16 v[128:143], v[204:207], a[12:15], v[128:143]
    v_and_b32 v80, s66, v65
    v_lshlrev_b32 v81, 16, v65
    ds_read_b64_tr_b16 v[196:197], v14 offset:12288
    ds_read_b64_tr_b16 v[198:199], v14 offset:12800
    v_mfma_f32_16x16x32_bf16 v[208:211], v[244:247], v[200:203], v[208:211]
    v_and_b32 v82, s66, v64
    v_lshlrev_b32 v83, 16, v64
    v_mfma_f32_16x16x32_bf16 v[208:211], v[232:235], v[204:207], v[208:211]
    s_waitcnt lgkmcnt(8) vmcnt(15)
    v_mfma_f32_32x32x16_bf16 v[112:127], v[176:179], a[16:19], v[112:127]
    v_fmac_f32 v144, v237, v80
    v_fmac_f32 v145, v237, v81
    ds_read_b64_tr_b16 v[200:201], v13 offset:14336
    ds_read_b64_tr_b16 v[202:203], v13 offset:14848
    v_mfma_f32_32x32x16_bf16 v[128:143], v[180:183], a[16:19], v[128:143]
    buffer_load_dwordx4 a[48:51], v2, s[40:43], s21 offen offset:0 sc1
    v_fmac_f32 v146, v237, v82
    buffer_load_dwordx4 a[52:55], v2, s[40:43], s21 offen offset:1024 sc1
    v_fmac_f32 v147, v237, v83
    v_and_b32 v80, s66, v67
    ds_read_b64_tr_b16 v[204:205], v14 offset:14336
    ds_read_b64_tr_b16 v[206:207], v14 offset:14848
    v_mfma_f32_16x16x32_bf16 v[208:211], v[244:247], v[176:179], v[208:211]
    v_lshlrev_b32 v81, 16, v67
    v_mfma_f32_16x16x32_bf16 v[208:211], v[232:235], v[180:183], v[208:211]
    v_and_b32 v82, s66, v66
    s_waitcnt lgkmcnt(8) vmcnt(16)
    v_mfma_f32_32x32x16_bf16 v[112:127], v[184:187], a[20:23], v[112:127]
    v_lshlrev_b32 v83, 16, v66
    v_fmac_f32 v148, v237, v80
    ds_read_b64_tr_b16 v[176:177], v15 offset:0
    ds_read_b64_tr_b16 v[178:179], v15 offset:512
    v_mfma_f32_32x32x16_bf16 v[128:143], v[188:191], a[20:23], v[128:143]
    v_fmac_f32 v149, v237, v81
    v_fmac_f32 v150, v237, v82
    v_fmac_f32 v151, v237, v83
    ds_read_b64_tr_b16 v[180:181], v16 offset:0
    ds_read_b64_tr_b16 v[182:183], v16 offset:512
    v_mfma_f32_16x16x32_bf16 v[208:211], v[244:247], v[184:187], v[208:211]
    v_and_b32 v80, s66, v69
    v_mfma_f32_16x16x32_bf16 v[208:211], v[232:235], v[188:191], v[208:211]
    s_waitcnt lgkmcnt(8) vmcnt(15)
    v_mfma_f32_32x32x16_bf16 v[112:127], v[192:195], a[24:27], v[112:127]
    v_lshlrev_b32 v81, 16, v69
    v_and_b32 v82, s66, v68
    v_lshlrev_b32 v83, 16, v68
    ds_read_b64_tr_b16 v[184:185], v15 offset:2048
    ds_read_b64_tr_b16 v[186:187], v15 offset:2560
    v_mfma_f32_32x32x16_bf16 v[128:143], v[196:199], a[24:27], v[128:143]
    buffer_load_dwordx4 a[56:59], v2, s[40:43], s21 offen offset:2048 sc1
    v_fmac_f32 v152, v237, v80
    buffer_load_dwordx4 a[60:63], v2, s[40:43], s21 offen offset:3072 sc1
    v_fmac_f32 v153, v237, v81
    v_fmac_f32 v154, v237, v82
    ds_read_b64_tr_b16 v[188:189], v16 offset:2048
    ds_read_b64_tr_b16 v[190:191], v16 offset:2560
    v_mfma_f32_16x16x32_bf16 v[208:211], v[244:247], v[192:195], v[208:211]
    v_fmac_f32 v155, v237, v83
    v_mfma_f32_16x16x32_bf16 v[208:211], v[232:235], v[196:199], v[208:211]
    s_waitcnt lgkmcnt(8) vmcnt(16)
    v_mfma_f32_32x32x16_bf16 v[112:127], v[200:203], a[28:31], v[112:127]
    v_and_b32 v80, s66, v71
    v_lshlrev_b32 v81, 16, v71
    v_and_b32 v82, s66, v70
    ds_read_b64_tr_b16 v[192:193], v15 offset:4096
    ds_read_b64_tr_b16 v[194:195], v15 offset:4608
    v_mfma_f32_32x32x16_bf16 v[128:143], v[204:207], a[28:31], v[128:143]
    v_lshlrev_b32 v83, 16, v70
    v_fmac_f32 v156, v237, v80
    v_fmac_f32 v157, v237, v81
    ds_read_b64_tr_b16 v[196:197], v16 offset:4096
    ds_read_b64_tr_b16 v[198:199], v16 offset:4608
    v_mfma_f32_16x16x32_bf16 v[208:211], v[244:247], v[200:203], v[208:211]
    buffer_load_dwordx4 a[64:67], v2, s[40:43], s14 offen offset:0 sc1
    v_fmac_f32 v158, v237, v82
    buffer_load_dwordx4 a[68:71], v2, s[40:43], s14 offen offset:1024 sc1
    v_mfma_f32_16x16x32_bf16 v[208:211], v[232:235], v[204:207], v[208:211]
    s_waitcnt lgkmcnt(8) vmcnt(17)
    v_mfma_f32_32x32x16_bf16 v[112:127], v[176:179], a[32:35], v[112:127]
    v_fmac_f32 v159, v237, v83
    v_cvt_pk_bf16_f32 v64, v144, v145
    v_cvt_pk_bf16_f32 v65, v146, v147
    ds_read_b64_tr_b16 v[200:201], v15 offset:6144
    ds_read_b64_tr_b16 v[202:203], v15 offset:6656
    v_mfma_f32_32x32x16_bf16 v[128:143], v[180:183], a[32:35], v[128:143]
    buffer_load_dwordx4 a[72:75], v2, s[40:43], s14 offen offset:2048 sc1
    ds_read_b64_tr_b16 v[204:205], v16 offset:6144
    buffer_load_dwordx4 a[76:79], v2, s[40:43], s14 offen offset:3072 sc1
    ds_read_b64_tr_b16 v[206:207], v16 offset:6656
    s_lshl_b32 s67, s3, 7
    s_add_u32 s67, s67, 65536
    v_add_u32 v13, s67, v5
    v_xor_b32 v14, 64, v13
    s_waitcnt lgkmcnt(8) vmcnt(18)
    v_mfma_f32_32x32x16_bf16 v[112:127], v[184:187], a[36:39], v[112:127]
    v_cvt_pk_bf16_f32 v66, v148, v149
    v_cvt_pk_bf16_f32 v67, v150, v151
    v_cvt_pk_bf16_f32 v68, v152, v153
    ds_read_b64_tr_b16 v[176:177], v15 offset:8192
    ds_read_b64_tr_b16 v[178:179], v15 offset:8704
    v_mfma_f32_32x32x16_bf16 v[128:143], v[188:191], a[36:39], v[128:143]
    ds_write_b32 v253, v208 offset:2048
    v_cvt_pk_bf16_f32 v69, v154, v155
    ds_read_b64_tr_b16 v[180:181], v16 offset:8192
    ds_read_b64_tr_b16 v[182:183], v16 offset:8704
    s_waitcnt lgkmcnt(9) vmcnt(9)
    v_mfma_f32_32x32x16_bf16 v[112:127], v[192:195], a[40:43], v[112:127]
    v_cvt_pk_bf16_f32 v70, v156, v157
    v_cvt_pk_bf16_f32 v71, v158, v159
    ds_write_b64 v22, v[64:65] offset:0
    ds_read_b64_tr_b16 v[184:185], v15 offset:10240
    ds_read_b64_tr_b16 v[186:187], v15 offset:10752
    v_mfma_f32_32x32x16_bf16 v[128:143], v[196:199], a[40:43], v[128:143]
    ds_write_b64 v22, v[66:67] offset:512
    ds_read_b64_tr_b16 v[188:189], v16 offset:10240
    ds_read_b64_tr_b16 v[190:191], v16 offset:10752
    s_waitcnt lgkmcnt(11) vmcnt(8)
    v_mfma_f32_32x32x16_bf16 v[112:127], v[200:203], a[44:47], v[112:127]
    buffer_load_dwordx4 a[80:83], v2, s[40:43], s22 offen offset:0 sc1
    ds_write_b64 v22, v[68:69] offset:1024
    buffer_load_dwordx4 a[84:87], v2, s[40:43], s22 offen offset:1024 sc1
    ds_write_b64 v22, v[70:71] offset:1536
    ds_read_b128 v[72:75], v21
    ds_read_b64_tr_b16 v[192:193], v15 offset:12288
    ds_read_b64_tr_b16 v[194:195], v15 offset:12800
    v_mfma_f32_32x32x16_bf16 v[128:143], v[204:207], a[44:47], v[128:143]
    ds_read_b128 v[76:79], v21 offset:1024
    v_lshrrev_b32 v22, 3, v1
    ds_read_b64_tr_b16 v[196:197], v16 offset:12288
    ds_read_b64_tr_b16 v[198:199], v16 offset:12800
    s_waitcnt lgkmcnt(14) vmcnt(9)
    v_mfma_f32_32x32x16_bf16 v[112:127], v[176:179], a[48:51], v[112:127]
    v_and_b32 v23, 7, v1
    v_lshlrev_b32 v23, 4, v23
    v_lshl_add_u32 v22, v22, 13, v23
    ds_read_b64_tr_b16 v[200:201], v15 offset:14336
    ds_read_b64_tr_b16 v[202:203], v15 offset:14848
    v_mfma_f32_32x32x16_bf16 v[128:143], v[180:183], a[48:51], v[128:143]
    ds_read_b64_tr_b16 v[204:205], v16 offset:14336
    ds_read_b64_tr_b16 v[206:207], v16 offset:14848
    s_waitcnt lgkmcnt(12) vmcnt(8)
    v_mfma_f32_32x32x16_bf16 v[112:127], v[184:187], a[52:55], v[112:127]
    buffer_load_dwordx4 a[88:91], v2, s[40:43], s22 offen offset:2048 sc1
    ds_read_b64_tr_b16 v[176:177], v13 offset:0
    buffer_load_dwordx4 a[92:95], v2, s[40:43], s22 offen offset:3072 sc1
    ds_read_b64_tr_b16 v[178:179], v13 offset:512
    v_mfma_f32_32x32x16_bf16 v[128:143], v[188:191], a[52:55], v[128:143]
    s_lshl_b32 s69, s59, 18
    s_lshl_b32 s68, s56, 17
    s_add_u32 s69, s69, s68
    s_lshl_b32 s68, s58, 1
    s_add_u32 s68, s68, s55
    s_lshl_b32 s68, s68, 7
    s_add_u32 s69, s69, s68
    s_add_u32 s69, s69, 14680064
    s_add_u32 s68, s69, 65536
    s_waitcnt lgkmcnt(11)
    buffer_store_dwordx4 v[72:75], v22, s[40:43], s69 offen sc1
    ds_read_b64_tr_b16 v[180:181], v14 offset:0
    ds_read_b64_tr_b16 v[182:183], v14 offset:512
    s_waitcnt lgkmcnt(8) vmcnt(10)
    v_mfma_f32_32x32x16_bf16 v[112:127], v[192:195], a[56:59], v[112:127]
    ds_read_b64_tr_b16 v[184:185], v13 offset:2048
    ds_read_b64_tr_b16 v[186:187], v13 offset:2560
    v_mfma_f32_32x32x16_bf16 v[128:143], v[196:199], a[56:59], v[128:143]
    buffer_store_dwordx4 v[76:79], v22, s[40:43], s68 offen sc1
    ds_read_b64_tr_b16 v[188:189], v14 offset:2048
    ds_read_b64_tr_b16 v[190:191], v14 offset:2560
    s_waitcnt lgkmcnt(8) vmcnt(10)
    v_mfma_f32_32x32x16_bf16 v[112:127], v[200:203], a[60:63], v[112:127]
    s_barrier
    ds_read_b64_tr_b16 v[192:193], v13 offset:4096
    ds_read_b64_tr_b16 v[194:195], v13 offset:4608
    v_mfma_f32_32x32x16_bf16 v[128:143], v[204:207], a[60:63], v[128:143]
    ds_read_b32 v208, v26 offset:2048
    ds_read_b64_tr_b16 v[196:197], v14 offset:4096
    ds_read_b64_tr_b16 v[198:199], v14 offset:4608
    s_waitcnt lgkmcnt(9) vmcnt(9)
    v_mfma_f32_32x32x16_bf16 v[112:127], v[176:179], a[64:67], v[112:127]
    ds_read_b32 v209, v26 offset:2304
    ds_read_b32 v210, v26 offset:2560
    ds_read_b64_tr_b16 v[200:201], v13 offset:6144
    ds_read_b64_tr_b16 v[202:203], v13 offset:6656
    v_mfma_f32_32x32x16_bf16 v[128:143], v[180:183], a[64:67], v[128:143]
    ds_read_b64_tr_b16 v[204:205], v14 offset:6144
    ds_read_b64_tr_b16 v[206:207], v14 offset:6656
    s_lshl_b32 s67, s95, 7
    s_add_u32 s67, s67, 65536
    v_add_u32 v15, s67, v5
    v_xor_b32 v16, 64, v15
    s_waitcnt lgkmcnt(11) vmcnt(8)
    v_mfma_f32_32x32x16_bf16 v[112:127], v[184:187], a[68:71], v[112:127]
    buffer_load_dwordx4 a[96:99], v2, s[40:43], s15 offen offset:0 sc1
    ds_read_b32 v211, v26 offset:2816
    buffer_load_dwordx4 a[100:103], v2, s[40:43], s15 offen offset:1024 sc1
    ds_read_b64_tr_b16 v[176:177], v13 offset:8192
    ds_read_b64_tr_b16 v[178:179], v13 offset:8704
    v_mfma_f32_32x32x16_bf16 v[128:143], v[188:191], a[68:71], v[128:143]
    ds_read_b64_tr_b16 v[180:181], v14 offset:8192
    ds_read_b64_tr_b16 v[182:183], v14 offset:8704
    s_waitcnt lgkmcnt(11) vmcnt(9)
    v_mfma_f32_32x32x16_bf16 v[112:127], v[192:195], a[72:75], v[112:127]
    s_waitcnt lgkmcnt(10)
    v_add_f32 v208, v208, v209
    s_waitcnt lgkmcnt(4)
    v_add_f32 v210, v210, v211
    v_add_f32 v208, v208, v210
    ds_write_b32 v253, v208 offset:3072
    ds_read_b64_tr_b16 v[184:185], v13 offset:10240
    ds_read_b64_tr_b16 v[186:187], v13 offset:10752
    v_mfma_f32_32x32x16_bf16 v[128:143], v[196:199], a[72:75], v[128:143]
    v_add_f32 v48, v48, v50
    ds_read_b64_tr_b16 v[188:189], v14 offset:10240
    ds_read_b64_tr_b16 v[190:191], v14 offset:10752
    s_waitcnt vmcnt(8)
    v_mfma_f32_32x32x16_bf16 v[112:127], v[200:203], a[76:79], v[112:127]
    buffer_load_dwordx4 a[104:107], v2, s[40:43], s15 offen offset:2048 sc1
    v_add_f32 v49, v49, v51
    buffer_load_dwordx4 a[108:111], v2, s[40:43], s15 offen offset:3072 sc1
    v_add_f32 v48, v48, v52
    v_add_f32 v48, v48, v54
    ds_read_b64_tr_b16 v[192:193], v13 offset:12288
    ds_read_b64_tr_b16 v[194:195], v13 offset:12800
    v_mfma_f32_32x32x16_bf16 v[128:143], v[204:207], a[76:79], v[128:143]
    v_add_f32 v49, v49, v53
    ds_read_b64_tr_b16 v[196:197], v14 offset:12288
    ds_read_b64_tr_b16 v[198:199], v14 offset:12800
    s_waitcnt lgkmcnt(9) vmcnt(9)
    v_mfma_f32_32x32x16_bf16 v[112:127], v[176:179], a[80:83], v[112:127]
    v_add_f32 v49, v49, v55
    v_add_f32 v48, v48, v56
    ds_read_b64_tr_b16 v[200:201], v13 offset:14336
    ds_read_b64_tr_b16 v[202:203], v13 offset:14848
    v_mfma_f32_32x32x16_bf16 v[128:143], v[180:183], a[80:83], v[128:143]
    v_add_f32 v48, v48, v58
    ds_read_b64_tr_b16 v[204:205], v14 offset:14336
    ds_read_b64_tr_b16 v[206:207], v14 offset:14848
    s_waitcnt lgkmcnt(8) vmcnt(8)
    v_mfma_f32_32x32x16_bf16 v[112:127], v[184:187], a[84:87], v[112:127]
    buffer_load_dwordx4 a[112:115], v2, s[40:43], s23 offen offset:0 sc1
    v_add_f32 v49, v49, v57
    buffer_load_dwordx4 a[116:119], v2, s[40:43], s23 offen offset:1024 sc1
    v_add_f32 v49, v49, v59
    v_add_f32 v48, v48, v60
    ds_read_b64_tr_b16 v[176:177], v15 offset:0
    ds_read_b64_tr_b16 v[178:179], v15 offset:512
    v_mfma_f32_32x32x16_bf16 v[128:143], v[188:191], a[84:87], v[128:143]
    v_add_f32 v48, v48, v62
    ds_read_b64_tr_b16 v[180:181], v16 offset:0
    ds_read_b64_tr_b16 v[182:183], v16 offset:512
    s_waitcnt lgkmcnt(8) vmcnt(9)
    v_mfma_f32_32x32x16_bf16 v[112:127], v[192:195], a[88:91], v[112:127]
    v_add_f32 v49, v49, v61
    v_add_f32 v49, v49, v63
    ds_read_b64_tr_b16 v[184:185], v15 offset:2048
    ds_read_b64_tr_b16 v[186:187], v15 offset:2560
    v_mfma_f32_32x32x16_bf16 v[128:143], v[196:199], a[88:91], v[128:143]
    v_mov_b32 v50, v48
    ds_read_b64_tr_b16 v[188:189], v16 offset:2048
    ds_read_b64_tr_b16 v[190:191], v16 offset:2560
    s_waitcnt lgkmcnt(8) vmcnt(8)
    v_mfma_f32_32x32x16_bf16 v[112:127], v[200:203], a[92:95], v[112:127]
    buffer_load_dwordx4 a[120:123], v2, s[40:43], s23 offen offset:2048 sc1
    v_permlane32_swap_b32 v48, v50
    buffer_load_dwordx4 a[124:127], v2, s[40:43], s23 offen offset:3072 sc1
    v_add_f32 v48, v48, v50
    s_add_u32 s84, s76, 32768
    buffer_load_dwordx4 a[160:163], v7, s[32:35], s84 offen
    buffer_load_dwordx4 a[164:167], v6, s[32:35], s84 offen offset:1024
    v_mov_b32 v51, v49
    ds_read_b64_tr_b16 v[192:193], v15 offset:4096
    ds_read_b64_tr_b16 v[194:195], v15 offset:4608
    v_mfma_f32_32x32x16_bf16 v[128:143], v[204:207], a[92:95], v[128:143]
    v_permlane32_swap_b32 v49, v51
    ds_read_b64_tr_b16 v[196:197], v16 offset:4096
    ds_read_b64_tr_b16 v[198:199], v16 offset:4608
    s_waitcnt lgkmcnt(8) vmcnt(9)
    v_mfma_f32_32x32x16_bf16 v[112:127], v[176:179], a[96:99], v[112:127]
    v_add_f32 v49, v49, v51
    v_mul_f32 v31, 0xbb000000, v48
    ds_read_b64_tr_b16 v[200:201], v15 offset:6144
    ds_read_b64_tr_b16 v[202:203], v15 offset:6656
    v_mfma_f32_32x32x16_bf16 v[128:143], v[180:183], a[96:99], v[128:143]
    v_mul_f32 v49, 0x3b000000, v49
    ds_read_b64_tr_b16 v[204:205], v16 offset:6144
    ds_read_b64_tr_b16 v[206:207], v16 offset:6656
    s_waitcnt lgkmcnt(8) vmcnt(8)
    v_mfma_f32_32x32x16_bf16 v[112:127], v[184:187], a[100:103], v[112:127]
    s_add_u32 s84, s77, 32768
    buffer_load_dwordx4 a[168:171], v7, s[32:35], s84 offen
    v_fma_f32 v49, -v31, v31, v49
    buffer_load_dwordx4 a[172:175], v6, s[32:35], s84 offen offset:1024
    v_max_f32 v49, 0, v49
    v_add_f32 v49, 0x3727c5ac, v49
    ds_read_b64_tr_b16 v[176:177], v15 offset:8192
    ds_read_b64_tr_b16 v[178:179], v15 offset:8704
    v_mfma_f32_32x32x16_bf16 v[128:143], v[188:191], a[100:103], v[128:143]
    ds_read_b64_tr_b16 v[180:181], v16 offset:8192
    ds_read_b64_tr_b16 v[182:183], v16 offset:8704
    s_waitcnt lgkmcnt(8) vmcnt(9)
    v_mfma_f32_32x32x16_bf16 v[112:127], v[192:195], a[104:107], v[112:127]
    v_rsq_f32 v48, v49
    v_sqrt_f32 v30, v49
    ds_read_b64_tr_b16 v[184:185], v15 offset:10240
    ds_read_b64_tr_b16 v[186:187], v15 offset:10752
    v_mfma_f32_32x32x16_bf16 v[128:143], v[196:199], a[104:107], v[128:143]
    ds_read_b64_tr_b16 v[188:189], v16 offset:10240
    ds_read_b64_tr_b16 v[190:191], v16 offset:10752
    s_waitcnt lgkmcnt(8) vmcnt(8)
    v_mfma_f32_32x32x16_bf16 v[112:127], v[200:203], a[108:111], v[112:127]
    s_add_u32 s84, s78, 32768
    buffer_load_dwordx4 a[176:179], v7, s[32:35], s84 offen
    v_mul_f32 v28, 0xc0135761, v48
    buffer_load_dwordx4 a[180:183], v6, s[32:35], s84 offen offset:1024
    v_mul_f32 v49, v48, v48
    v_mul_f32 v49, v49, v48
    ds_read_b64_tr_b16 v[192:193], v15 offset:12288
    ds_read_b64_tr_b16 v[194:195], v15 offset:12800
    v_mfma_f32_32x32x16_bf16 v[128:143], v[204:207], a[108:111], v[128:143]
    v_mul_f32 v29, 0xbdd2d3e8, v49
    ds_read_b64_tr_b16 v[196:197], v16 offset:12288
    ds_read_b64_tr_b16 v[198:199], v16 offset:12800
    s_waitcnt lgkmcnt(8) vmcnt(9)
    v_mfma_f32_32x32x16_bf16 v[112:127], v[176:179], a[112:115], v[112:127]
    ds_read_b128 v[92:95], v20 offset:0
    ds_read_b64_tr_b16 v[200:201], v15 offset:14336
    ds_read_b64_tr_b16 v[202:203], v15 offset:14848
    v_mfma_f32_32x32x16_bf16 v[128:143], v[180:183], a[112:115], v[128:143]
    ds_read_b128 v[96:99], v20 offset:32
    ds_read_b64_tr_b16 v[204:205], v16 offset:14336
    ds_read_b64_tr_b16 v[206:207], v16 offset:14848
    s_waitcnt lgkmcnt(10) vmcnt(8)
    v_mfma_f32_32x32x16_bf16 v[112:127], v[184:187], a[116:119], v[112:127]
    s_add_u32 s84, s72, 65536
    buffer_load_dwordx4 a[184:187], v7, s[32:35], s84 offen
    ds_read_b128 v[100:103], v20 offset:64
    buffer_load_dwordx4 a[188:191], v6, s[32:35], s84 offen offset:1024
    ds_read_b128 v[104:107], v20 offset:96
    v_mfma_f32_32x32x16_bf16 v[128:143], v[188:191], a[116:119], v[128:143]
    v_add_u32_e64 v18, s64, 2
    s_mov_b64 exec, 1
    buffer_store_dword v18, v255, s[40:43], s1 offen sc1
    s_mov_b64 exec, -1
    s_waitcnt lgkmcnt(8) vmcnt(10)
    v_mfma_f32_32x32x16_bf16 v[112:127], v[192:195], a[120:123], v[112:127]
    ds_read_b128 v[160:163], v20 offset:128
    ds_read_b128 v[164:167], v20 offset:160
    v_mfma_f32_32x32x16_bf16 v[128:143], v[196:199], a[120:123], v[128:143]
    ds_read_b128 v[168:171], v20 offset:192
    ds_read_b128 v[172:175], v20 offset:224
    s_waitcnt lgkmcnt(6) vmcnt(9)
    v_mfma_f32_32x32x16_bf16 v[112:127], v[200:203], a[124:127], v[112:127]
    v_mfma_f32_32x32x16_bf16 v[128:143], v[204:207], a[124:127], v[128:143]
    .p2align 3
    s_nop 10
    v_pk_fma_f32 v[112:113], v[92:93], v[30:31], v[112:113] op_sel:[0,1,0] op_sel_hi:[1,1,1]
    v_pk_fma_f32 v[114:115], v[94:95], v[30:31], v[114:115] op_sel:[0,1,0] op_sel_hi:[1,1,1]
    v_pk_fma_f32 v[116:117], v[96:97], v[30:31], v[116:117] op_sel:[0,1,0] op_sel_hi:[1,1,1]
    v_pk_fma_f32 v[118:119], v[98:99], v[30:31], v[118:119] op_sel:[0,1,0] op_sel_hi:[1,1,1]
    v_pk_mul_f32 v[224:225], v[112:113], v[112:113]
    v_pk_mul_f32 v[226:227], v[114:115], v[114:115]
    v_pk_mul_f32 v[228:229], v[116:117], v[116:117]
    v_pk_mul_f32 v[230:231], v[118:119], v[118:119]
    v_pk_fma_f32 v[224:225], v[224:225], v[28:29], v[28:29] op_sel:[0,1,0] op_sel_hi:[1,1,0]
    v_pk_fma_f32 v[226:227], v[226:227], v[28:29], v[28:29] op_sel:[0,1,0] op_sel_hi:[1,1,0]
    s_add_u32 s84, s73, 65536
    buffer_load_dwordx4 a[192:195], v7, s[32:35], s84 offen
    buffer_load_dwordx4 a[196:199], v6, s[32:35], s84 offen offset:1024
    v_pk_fma_f32 v[228:229], v[228:229], v[28:29], v[28:29] op_sel:[0,1,0] op_sel_hi:[1,1,0]
    v_pk_fma_f32 v[230:231], v[230:231], v[28:29], v[28:29] op_sel:[0,1,0] op_sel_hi:[1,1,0]
    v_pk_mul_f32 v[224:225], v[224:225], v[112:113]
    v_pk_mul_f32 v[226:227], v[226:227], v[114:115]
    v_pk_mul_f32 v[228:229], v[228:229], v[116:117]
    v_pk_mul_f32 v[230:231], v[230:231], v[118:119]
    v_exp_f32 v224, v224
    v_exp_f32 v225, v225
    v_exp_f32 v226, v226
    v_exp_f32 v227, v227
    v_exp_f32 v228, v228
    v_exp_f32 v229, v229
    v_exp_f32 v230, v230
    v_exp_f32 v231, v231
    v_pk_fma_f32 v[224:225], v[224:225], v[30:31], v[30:31] op_sel:[0,0,0] op_sel_hi:[1,0,0]
    v_pk_fma_f32 v[226:227], v[226:227], v[30:31], v[30:31] op_sel:[0,0,0] op_sel_hi:[1,0,0]
    v_pk_fma_f32 v[228:229], v[228:229], v[30:31], v[30:31] op_sel:[0,0,0] op_sel_hi:[1,0,0]
    v_pk_fma_f32 v[230:231], v[230:231], v[30:31], v[30:31] op_sel:[0,0,0] op_sel_hi:[1,0,0]
    v_rcp_f32 v224, v224
    v_rcp_f32 v225, v225
    v_rcp_f32 v226, v226
    v_rcp_f32 v227, v227
    v_rcp_f32 v228, v228
    v_rcp_f32 v229, v229
    v_rcp_f32 v230, v230
    v_rcp_f32 v231, v231
    v_pk_mul_f32 v[224:225], v[224:225], v[112:113]
    v_pk_mul_f32 v[226:227], v[226:227], v[114:115]
    v_pk_mul_f32 v[228:229], v[228:229], v[116:117]
    v_pk_mul_f32 v[230:231], v[230:231], v[118:119]
    v_cvt_pk_bf16_f32 v208, v224, v225
    s_add_u32 s84, s74, 65536
    buffer_load_dwordx4 a[200:203], v7, s[32:35], s84 offen
    buffer_load_dwordx4 a[204:207], v6, s[32:35], s84 offen offset:1024
    v_cvt_pk_bf16_f32 v209, v226, v227
    v_cvt_pk_bf16_f32 v210, v228, v229
    v_cvt_pk_bf16_f32 v211, v230, v231
    .p2align 3
    s_waitcnt lgkmcnt(5)
    v_pk_fma_f32 v[120:121], v[100:101], v[30:31], v[120:121] op_sel:[0,1,0] op_sel_hi:[1,1,1]
    v_pk_fma_f32 v[122:123], v[102:103], v[30:31], v[122:123] op_sel:[0,1,0] op_sel_hi:[1,1,1]
    s_waitcnt lgkmcnt(4)
    v_pk_fma_f32 v[124:125], v[104:105], v[30:31], v[124:125] op_sel:[0,1,0] op_sel_hi:[1,1,1]
    v_pk_fma_f32 v[126:127], v[106:107], v[30:31], v[126:127] op_sel:[0,1,0] op_sel_hi:[1,1,1]
    v_pk_mul_f32 v[224:225], v[120:121], v[120:121]
    v_pk_mul_f32 v[226:227], v[122:123], v[122:123]
    v_pk_mul_f32 v[228:229], v[124:125], v[124:125]
    v_pk_mul_f32 v[230:231], v[126:127], v[126:127]
    v_pk_fma_f32 v[224:225], v[224:225], v[28:29], v[28:29] op_sel:[0,1,0] op_sel_hi:[1,1,0]
    v_pk_fma_f32 v[226:227], v[226:227], v[28:29], v[28:29] op_sel:[0,1,0] op_sel_hi:[1,1,0]
    v_pk_fma_f32 v[228:229], v[228:229], v[28:29], v[28:29] op_sel:[0,1,0] op_sel_hi:[1,1,0]
    v_pk_fma_f32 v[230:231], v[230:231], v[28:29], v[28:29] op_sel:[0,1,0] op_sel_hi:[1,1,0]
    v_pk_mul_f32 v[224:225], v[224:225], v[120:121]
    v_pk_mul_f32 v[226:227], v[226:227], v[122:123]
    v_pk_mul_f32 v[228:229], v[228:229], v[124:125]
    v_pk_mul_f32 v[230:231], v[230:231], v[126:127]
    v_exp_f32 v224, v224
    v_exp_f32 v225, v225
    v_exp_f32 v226, v226
    v_exp_f32 v227, v227
    v_exp_f32 v228, v228
    v_exp_f32 v229, v229
    v_exp_f32 v230, v230
    v_exp_f32 v231, v231
    v_pk_fma_f32 v[224:225], v[224:225], v[30:31], v[30:31] op_sel:[0,0,0] op_sel_hi:[1,0,0]
    v_pk_fma_f32 v[226:227], v[226:227], v[30:31], v[30:31] op_sel:[0,0,0] op_sel_hi:[1,0,0]
    v_pk_fma_f32 v[228:229], v[228:229], v[30:31], v[30:31] op_sel:[0,0,0] op_sel_hi:[1,0,0]
    v_pk_fma_f32 v[230:231], v[230:231], v[30:31], v[30:31] op_sel:[0,0,0] op_sel_hi:[1,0,0]
    v_rcp_f32 v224, v224
    v_rcp_f32 v225, v225
    v_rcp_f32 v226, v226
    s_add_u32 s84, s75, 65536
    buffer_load_dwordx4 a[208:211], v7, s[32:35], s84 offen
    buffer_load_dwordx4 a[212:215], v6, s[32:35], s84 offen offset:1024
    v_rcp_f32 v227, v227
    v_rcp_f32 v228, v228
    v_rcp_f32 v229, v229
    v_rcp_f32 v230, v230
    v_rcp_f32 v231, v231
    v_pk_mul_f32 v[224:225], v[224:225], v[120:121]
    v_pk_mul_f32 v[226:227], v[226:227], v[122:123]
    v_pk_mul_f32 v[228:229], v[228:229], v[124:125]
    v_pk_mul_f32 v[230:231], v[230:231], v[126:127]
    v_cvt_pk_bf16_f32 v212, v224, v225
    v_cvt_pk_bf16_f32 v213, v226, v227
    v_cvt_pk_bf16_f32 v214, v228, v229
    v_cvt_pk_bf16_f32 v215, v230, v231
    buffer_store_dwordx4 v[208:211], v2, s[40:43], s89 offen sc1
    buffer_store_dwordx4 v[212:215], v2, s[40:43], s89 offen offset:2048 sc1
    s_add_u32 s89, s89, 57344
    s_nop 0
    s_barrier
    s_lshl_b32 s67, s46, 7
    s_add_u32 s67, s67, 0
    v_add_u32 v13, s67, v5
    v_xor_b32 v14, 64, v13
    ds_read_b64_tr_b16 v[144:145], v14 offset:0
    ds_read_b64_tr_b16 v[146:147], v14 offset:512
    ds_read_b64_tr_b16 v[148:149], v14 offset:2048
    ds_read_b64_tr_b16 v[150:151], v14 offset:2560
    ds_read_b64_tr_b16 v[152:153], v14 offset:4096
    ds_read_b64_tr_b16 v[154:155], v14 offset:4608
    ds_read_b64_tr_b16 v[176:177], v13 offset:0
    ds_read_b64_tr_b16 v[178:179], v13 offset:512
    ds_read_b64_tr_b16 v[180:181], v13 offset:2048
    ds_read_b64_tr_b16 v[182:183], v13 offset:2560
    ds_read_b64_tr_b16 v[184:185], v13 offset:4096
    ds_read_b64_tr_b16 v[186:187], v13 offset:4608
    ds_read_b64_tr_b16 v[188:189], v13 offset:6144
    ds_read_b64_tr_b16 v[190:191], v13 offset:6656
    s_add_u32 m0, s80, 65536
    s_add_u32 s84, s72, 0
    buffer_load_dwordx4 v7, s[32:35], s84 offen  lds
    buffer_load_dwordx4 v6, s[32:35], s84 offen offset:1024  lds
    ds_read_b64_tr_b16 v[192:193], v13 offset:8192
    ds_read_b64_tr_b16 v[194:195], v13 offset:8704
    s_lshl_b32 s67, s47, 7
    s_add_u32 s67, s67, 0
    v_add_u32 v15, s67, v5
    .p2align 3
    s_waitcnt lgkmcnt(15)
    v_pk_fma_f32 v[128:129], v[160:161], v[30:31], v[128:129] op_sel:[0,1,0] op_sel_hi:[1,1,1]
    v_pk_fma_f32 v[130:131], v[162:163], v[30:31], v[130:131] op_sel:[0,1,0] op_sel_hi:[1,1,1]
    v_pk_fma_f32 v[132:133], v[164:165], v[30:31], v[132:133] op_sel:[0,1,0] op_sel_hi:[1,1,1]
    v_pk_fma_f32 v[134:135], v[166:167], v[30:31], v[134:135] op_sel:[0,1,0] op_sel_hi:[1,1,1]
    v_pk_mul_f32 v[224:225], v[128:129], v[128:129]
    v_pk_mul_f32 v[226:227], v[130:131], v[130:131]
    v_pk_mul_f32 v[228:229], v[132:133], v[132:133]
    v_pk_mul_f32 v[230:231], v[134:135], v[134:135]
    v_pk_fma_f32 v[224:225], v[224:225], v[28:29], v[28:29] op_sel:[0,1,0] op_sel_hi:[1,1,0]
    v_pk_fma_f32 v[226:227], v[226:227], v[28:29], v[28:29] op_sel:[0,1,0] op_sel_hi:[1,1,0]
    v_pk_fma_f32 v[228:229], v[228:229], v[28:29], v[28:29] op_sel:[0,1,0] op_sel_hi:[1,1,0]
    v_pk_fma_f32 v[230:231], v[230:231], v[28:29], v[28:29] op_sel:[0,1,0] op_sel_hi:[1,1,0]
    v_pk_mul_f32 v[224:225], v[224:225], v[128:129]
    v_pk_mul_f32 v[226:227], v[226:227], v[130:131]
    v_pk_mul_f32 v[228:229], v[228:229], v[132:133]
    v_pk_mul_f32 v[230:231], v[230:231], v[134:135]
    v_exp_f32 v224, v224
    v_exp_f32 v225, v225
    v_exp_f32 v226, v226
    v_exp_f32 v227, v227
    v_exp_f32 v228, v228
    v_exp_f32 v229, v229
    v_exp_f32 v230, v230
    v_exp_f32 v231, v231
    v_pk_fma_f32 v[224:225], v[224:225], v[30:31], v[30:31] op_sel:[0,0,0] op_sel_hi:[1,0,0]
    v_pk_fma_f32 v[226:227], v[226:227], v[30:31], v[30:31] op_sel:[0,0,0] op_sel_hi:[1,0,0]
    v_pk_fma_f32 v[228:229], v[228:229], v[30:31], v[30:31] op_sel:[0,0,0] op_sel_hi:[1,0,0]
    v_pk_fma_f32 v[230:231], v[230:231], v[30:31], v[30:31] op_sel:[0,0,0] op_sel_hi:[1,0,0]
    v_rcp_f32 v224, v224
    v_rcp_f32 v225, v225
    s_add_u32 m0, s80, 67584
    s_add_u32 s84, s73, 0
    buffer_load_dwordx4 v7, s[32:35], s84 offen  lds
    buffer_load_dwordx4 v6, s[32:35], s84 offen offset:1024  lds
    v_rcp_f32 v226, v226
    v_rcp_f32 v227, v227
    v_rcp_f32 v228, v228
    v_rcp_f32 v229, v229
    v_rcp_f32 v230, v230
    v_rcp_f32 v231, v231
    v_pk_mul_f32 v[224:225], v[224:225], v[128:129]
    v_pk_mul_f32 v[226:227], v[226:227], v[130:131]
    v_pk_mul_f32 v[228:229], v[228:229], v[132:133]
    v_pk_mul_f32 v[230:231], v[230:231], v[134:135]
    v_cvt_pk_bf16_f32 v216, v224, v225
    v_cvt_pk_bf16_f32 v217, v226, v227
    v_cvt_pk_bf16_f32 v218, v228, v229
    v_cvt_pk_bf16_f32 v219, v230, v231
    .p2align 3
    v_pk_fma_f32 v[136:137], v[168:169], v[30:31], v[136:137] op_sel:[0,1,0] op_sel_hi:[1,1,1]
    v_pk_fma_f32 v[138:139], v[170:171], v[30:31], v[138:139] op_sel:[0,1,0] op_sel_hi:[1,1,1]
    v_pk_fma_f32 v[140:141], v[172:173], v[30:31], v[140:141] op_sel:[0,1,0] op_sel_hi:[1,1,1]
    v_pk_fma_f32 v[142:143], v[174:175], v[30:31], v[142:143] op_sel:[0,1,0] op_sel_hi:[1,1,1]
    v_pk_mul_f32 v[224:225], v[136:137], v[136:137]
    v_pk_mul_f32 v[226:227], v[138:139], v[138:139]
    v_pk_mul_f32 v[228:229], v[140:141], v[140:141]
    v_pk_mul_f32 v[230:231], v[142:143], v[142:143]
    v_pk_fma_f32 v[224:225], v[224:225], v[28:29], v[28:29] op_sel:[0,1,0] op_sel_hi:[1,1,0]
    v_pk_fma_f32 v[226:227], v[226:227], v[28:29], v[28:29] op_sel:[0,1,0] op_sel_hi:[1,1,0]
    v_pk_fma_f32 v[228:229], v[228:229], v[28:29], v[28:29] op_sel:[0,1,0] op_sel_hi:[1,1,0]
    v_pk_fma_f32 v[230:231], v[230:231], v[28:29], v[28:29] op_sel:[0,1,0] op_sel_hi:[1,1,0]
    v_pk_mul_f32 v[224:225], v[224:225], v[136:137]
    v_pk_mul_f32 v[226:227], v[226:227], v[138:139]
    v_pk_mul_f32 v[228:229], v[228:229], v[140:141]
    v_pk_mul_f32 v[230:231], v[230:231], v[142:143]
    v_exp_f32 v224, v224
    v_exp_f32 v225, v225
    v_exp_f32 v226, v226
    s_add_u32 m0, s80, 69632
    s_add_u32 s84, s74, 0
    buffer_load_dwordx4 v7, s[32:35], s84 offen  lds
    buffer_load_dwordx4 v6, s[32:35], s84 offen offset:1024  lds
    v_exp_f32 v227, v227
    v_exp_f32 v228, v228
    v_exp_f32 v229, v229
    v_exp_f32 v230, v230
    v_exp_f32 v231, v231
    v_pk_fma_f32 v[224:225], v[224:225], v[30:31], v[30:31] op_sel:[0,0,0] op_sel_hi:[1,0,0]
    v_pk_fma_f32 v[226:227], v[226:227], v[30:31], v[30:31] op_sel:[0,0,0] op_sel_hi:[1,0,0]
    v_pk_fma_f32 v[228:229], v[228:229], v[30:31], v[30:31] op_sel:[0,0,0] op_sel_hi:[1,0,0]
    v_pk_fma_f32 v[230:231], v[230:231], v[30:31], v[30:31] op_sel:[0,0,0] op_sel_hi:[1,0,0]
    v_rcp_f32 v224, v224
    v_rcp_f32 v225, v225
    v_rcp_f32 v226, v226
    v_rcp_f32 v227, v227
    v_rcp_f32 v228, v228
    v_rcp_f32 v229, v229
    v_rcp_f32 v230, v230
    v_rcp_f32 v231, v231
    v_pk_mul_f32 v[224:225], v[224:225], v[136:137]
    v_pk_mul_f32 v[226:227], v[226:227], v[138:139]
    v_pk_mul_f32 v[228:229], v[228:229], v[140:141]
    v_pk_mul_f32 v[230:231], v[230:231], v[142:143]
    v_cvt_pk_bf16_f32 v220, v224, v225
    v_cvt_pk_bf16_f32 v221, v226, v227
    v_cvt_pk_bf16_f32 v222, v228, v229
    v_cvt_pk_bf16_f32 v223, v230, v231
    buffer_store_dwordx4 v[216:219], v2, s[40:43], s89 offen sc1
    buffer_store_dwordx4 v[220:223], v2, s[40:43], s89 offen offset:2048 sc1
    s_add_u32 s89, s89, 57344
    s_nop 0
    s_lshl_b32 s69, s55, 10
    v_add_u32 v10, s69, v2
    v_xor_b32 v11, 1024, v10
    v_add_u32 v12, s80, v2
    v_lshlrev_b32 v22, 2, v1
    s_waitcnt lgkmcnt(8)
    v_mfma_f32_32x32x16_bf16 v[112:127], v[176:179], a[0:3], 0
    s_add_u32 m0, s80, 71680
    s_add_u32 s84, s75, 0
    ds_read_b64_tr_b16 v[196:197], v13 offset:10240
    ds_read_b64_tr_b16 v[198:199], v13 offset:10752
    v_mfma_f32_16x16x32_bf16 v[208:211], v[244:247], v[176:179], 0
    buffer_load_dwordx4 v7, s[32:35], s84 offen  lds
    ds_read_b64_tr_b16 v[156:157], v14 offset:6144
    buffer_load_dwordx4 v6, s[32:35], s84 offen offset:1024  lds
    ds_read_b64_tr_b16 v[158:159], v14 offset:6656
    v_mfma_f32_16x16x32_bf16 v[208:211], v[232:235], v[144:147], v[208:211]
    s_waitcnt lgkmcnt(10)
    v_mfma_f32_32x32x16_bf16 v[112:127], v[180:183], a[4:7], v[112:127]
    ds_read_b64_tr_b16 v[176:177], v13 offset:12288
    ds_read_b64_tr_b16 v[178:179], v13 offset:12800
    v_mfma_f32_16x16x32_bf16 v[208:211], v[244:247], v[180:183], v[208:211]
    ds_read_b64_tr_b16 v[144:145], v14 offset:8192
    ds_read_b64_tr_b16 v[146:147], v14 offset:8704
    v_mfma_f32_16x16x32_bf16 v[208:211], v[232:235], v[148:151], v[208:211]
    v_add_u32_e64 v18, s64, 3
    s_waitcnt vmcnt(10)
    s_mov_b64 exec, 1
    buffer_store_dword v18, v255, s[40:43], s79 offen sc1
    s_mov_b64 exec, -1
    s_waitcnt lgkmcnt(12)
    v_mfma_f32_32x32x16_bf16 v[112:127], v[184:187], a[8:11], v[112:127]
    ds_read_b64_tr_b16 v[180:181], v13 offset:14336
    ds_read_b64_tr_b16 v[182:183], v13 offset:14848
    v_mfma_f32_16x16x32_bf16 v[208:211], v[244:247], v[184:187], v[208:211]
    ds_read_b64_tr_b16 v[148:149], v14 offset:10240
    ds_read_b64_tr_b16 v[150:151], v14 offset:10752
    v_mfma_f32_16x16x32_bf16 v[208:211], v[232:235], v[152:155], v[208:211]
    s_waitcnt lgkmcnt(14)
    v_mfma_f32_32x32x16_bf16 v[112:127], v[188:191], a[12:15], v[112:127]
    ds_read_b64_tr_b16 v[184:185], v15 offset:0
    ds_read_b64_tr_b16 v[186:187], v15 offset:512
    v_mfma_f32_16x16x32_bf16 v[208:211], v[244:247], v[188:191], v[208:211]
    ds_read_b64_tr_b16 v[152:153], v14 offset:12288
    ds_read_b64_tr_b16 v[154:155], v14 offset:12800
    s_waitcnt lgkmcnt(12)
    v_mfma_f32_16x16x32_bf16 v[208:211], v[232:235], v[156:159], v[208:211]
    v_mfma_f32_32x32x16_bf16 v[112:127], v[192:195], a[16:19], v[112:127]
    ds_read_b64_tr_b16 v[188:189], v15 offset:2048
    ds_read_b64_tr_b16 v[190:191], v15 offset:2560
    v_mfma_f32_16x16x32_bf16 v[208:211], v[244:247], v[192:195], v[208:211]
    ds_read_b64_tr_b16 v[156:157], v14 offset:14336
    ds_read_b64_tr_b16 v[158:159], v14 offset:14848
    s_waitcnt lgkmcnt(12)
    v_mfma_f32_16x16x32_bf16 v[208:211], v[232:235], v[144:147], v[208:211]
    s_add_u32 m0, s80, 73728
    s_add_u32 s84, s76, 0
    v_mfma_f32_32x32x16_bf16 v[112:127], v[196:199], a[20:23], v[112:127]
    buffer_load_dwordx4 v7, s[32:35], s84 offen  lds
    ds_read_b64_tr_b16 v[192:193], v15 offset:4096
    buffer_load_dwordx4 v6, s[32:35], s84 offen offset:1024  lds
    ds_read_b64_tr_b16 v[194:195], v15 offset:4608
    v_mfma_f32_16x16x32_bf16 v[208:211], v[244:247], v[196:199], v[208:211]
    s_waitcnt lgkmcnt(10)
    v_mfma_f32_16x16x32_bf16 v[208:211], v[232:235], v[148:151], v[208:211]
    v_mfma_f32_32x32x16_bf16 v[112:127], v[176:179], a[24:27], v[112:127]
    ds_read_b64_tr_b16 v[196:197], v15 offset:6144
    ds_read_b64_tr_b16 v[198:199], v15 offset:6656
    v_mfma_f32_16x16x32_bf16 v[208:211], v[244:247], v[176:179], v[208:211]
    s_waitcnt lgkmcnt(8)
    v_mfma_f32_16x16x32_bf16 v[208:211], v[232:235], v[152:155], v[208:211]
    s_lshl_b32 s67, s3, 7
    s_add_u32 s67, s67, 0
    v_add_u32 v13, s67, v5
    v_mfma_f32_32x32x16_bf16 v[112:127], v[180:183], a[28:31], v[112:127]
    v_add_u32_e64 v18, s64, 4
    s_waitcnt vmcnt(8)
    s_add_u32 m0, s80, 75776
    s_add_u32 s84, s77, 0
    buffer_load_dwordx4 v7, s[32:35], s84 offen  lds
    buffer_load_dwordx4 v6, s[32:35], s84 offen offset:1024  lds
    s_waitcnt vmcnt(7)
    s_mov_b64 exec, 1
    buffer_store_dword v18, v255, s[40:43], s79 offen sc1
    s_mov_b64 exec, -1
    s_add_u32 m0, s80, 77824
    s_add_u32 s84, s78, 0
    buffer_load_dwordx4 v7, s[32:35], s84 offen  lds
    buffer_load_dwordx4 v6, s[32:35], s84 offen offset:1024  lds
    ds_read_b64_tr_b16 v[176:177], v15 offset:8192
    ds_read_b64_tr_b16 v[178:179], v15 offset:8704
    v_mfma_f32_16x16x32_bf16 v[208:211], v[244:247], v[180:183], v[208:211]
    s_waitcnt lgkmcnt(6)
    v_mfma_f32_16x16x32_bf16 v[208:211], v[232:235], v[156:159], v[208:211]
    v_mfma_f32_32x32x16_bf16 v[112:127], v[184:187], a[32:35], v[112:127]
    ds_read_b64_tr_b16 v[180:181], v15 offset:10240
    ds_read_b64_tr_b16 v[182:183], v15 offset:10752
    v_mfma_f32_32x32x16_bf16 v[112:127], v[188:191], a[36:39], v[112:127]
    ds_read_b64_tr_b16 v[184:185], v15 offset:12288
    ds_read_b64_tr_b16 v[186:187], v15 offset:12800
    s_waitcnt lgkmcnt(8)
    v_mfma_f32_32x32x16_bf16 v[112:127], v[192:195], a[40:43], v[112:127]
    ds_read_b64_tr_b16 v[188:189], v15 offset:14336
    ds_read_b64_tr_b16 v[190:191], v15 offset:14848
    s_waitcnt lgkmcnt(8)
    v_mfma_f32_32x32x16_bf16 v[112:127], v[196:199], a[44:47], v[112:127]
    ds_write_b32 v253, v208 offset:0
    ds_read_b64_tr_b16 v[192:193], v13 offset:0
    ds_read_b64_tr_b16 v[194:195], v13 offset:512
    s_waitcnt lgkmcnt(9)
    v_mfma_f32_32x32x16_bf16 v[112:127], v[176:179], a[48:51], v[112:127]
    s_add_u32 s84, s76, 65536
    buffer_load_dwordx4 a[216:219], v7, s[32:35], s84 offen
    ds_read_b64_tr_b16 v[196:197], v13 offset:2048
    buffer_load_dwordx4 a[220:223], v6, s[32:35], s84 offen offset:1024
    ds_read_b64_tr_b16 v[198:199], v13 offset:2560
    s_waitcnt lgkmcnt(9)
    v_mfma_f32_32x32x16_bf16 v[112:127], v[180:183], a[52:55], v[112:127]
    ds_read_b64_tr_b16 v[176:177], v13 offset:4096
    ds_read_b64_tr_b16 v[178:179], v13 offset:4608
    s_waitcnt lgkmcnt(9)
    v_mfma_f32_32x32x16_bf16 v[112:127], v[184:187], a[56:59], v[112:127]
    ds_read_b64_tr_b16 v[180:181], v13 offset:6144
    ds_read_b64_tr_b16 v[182:183], v13 offset:6656
    s_lshl_b32 s67, s95, 7
    s_add_u32 s67, s67, 0
    v_add_u32 v15, s67, v5
    s_waitcnt lgkmcnt(9)
    v_mfma_f32_32x32x16_bf16 v[112:127], v[188:191], a[60:63], v[112:127]
    s_waitcnt lgkmcnt(8)
    s_barrier
    ds_read_b64_tr_b16 v[184:185], v13 offset:8192
    ds_read_b64_tr_b16 v[186:187], v13 offset:8704
    s_waitcnt lgkmcnt(8)
    v_mfma_f32_32x32x16_bf16 v[112:127], v[192:195], a[64:67], v[112:127]
    ds_read_b32 v208, v26 offset:0
    ds_read_b64_tr_b16 v[188:189], v13 offset:10240
    ds_read_b64_tr_b16 v[190:191], v13 offset:10752
    s_waitcnt lgkmcnt(9)
    v_mfma_f32_32x32x16_bf16 v[112:127], v[196:199], a[68:71], v[112:127]
    s_add_u32 s84, s77, 65536
    buffer_load_dwordx4 a[224:227], v7, s[32:35], s84 offen
    ds_read_b32 v209, v26 offset:256
    buffer_load_dwordx4 a[228:231], v6, s[32:35], s84 offen offset:1024
    ds_read_b64_tr_b16 v[192:193], v13 offset:12288
    ds_read_b64_tr_b16 v[194:195], v13 offset:12800
    s_waitcnt lgkmcnt(10)
    v_mfma_f32_32x32x16_bf16 v[112:127], v[176:179], a[72:75], v[112:127]
    ds_read_b32 v210, v26 offset:512
    ds_read_b32 v211, v26 offset:768
    ds_read_b64_tr_b16 v[196:197], v13 offset:14336
    ds_read_b64_tr_b16 v[198:199], v13 offset:14848
    s_waitcnt lgkmcnt(12)
    v_mfma_f32_32x32x16_bf16 v[112:127], v[180:183], a[76:79], v[112:127]
    ds_read_b64_tr_b16 v[176:177], v15 offset:0
    ds_read_b64_tr_b16 v[178:179], v15 offset:512
    s_waitcnt lgkmcnt(12)
    v_mfma_f32_32x32x16_bf16 v[112:127], v[184:187], a[80:83], v[112:127]
    ds_read_b64_tr_b16 v[180:181], v15 offset:2048
    ds_read_b64_tr_b16 v[182:183], v15 offset:2560
    s_waitcnt lgkmcnt(11)
    v_mfma_f32_32x32x16_bf16 v[112:127], v[188:191], a[84:87], v[112:127]
    s_waitcnt lgkmcnt(10)
    v_add_f32 v208, v208, v209
    s_waitcnt lgkmcnt(6)
    v_add_f32 v210, v210, v211
    v_add_f32 v208, v208, v210
    ds_write_b32 v253, v208 offset:3072
    ds_read_b64_tr_b16 v[184:185], v15 offset:4096
    ds_read_b64_tr_b16 v[186:187], v15 offset:4608
    v_mfma_f32_32x32x16_bf16 v[112:127], v[192:195], a[88:91], v[112:127]
    ds_read_b64_tr_b16 v[188:189], v15 offset:6144
    ds_read_b64_tr_b16 v[190:191], v15 offset:6656
    s_waitcnt lgkmcnt(9)
    v_mfma_f32_32x32x16_bf16 v[112:127], v[196:199], a[92:95], v[112:127]
    ds_read_b128 v[144:147], v20 offset:0
    ds_read_b64_tr_b16 v[192:193], v15 offset:8192
    ds_read_b64_tr_b16 v[194:195], v15 offset:8704
    s_waitcnt lgkmcnt(10)
    v_mfma_f32_32x32x16_bf16 v[112:127], v[176:179], a[96:99], v[112:127]
    ds_read_b128 v[148:151], v20 offset:32
    ds_read_b64_tr_b16 v[196:197], v15 offset:10240
    ds_read_b64_tr_b16 v[198:199], v15 offset:10752
    s_waitcnt lgkmcnt(11)
    v_mfma_f32_32x32x16_bf16 v[112:127], v[180:183], a[100:103], v[112:127]
    ds_read_b64_tr_b16 v[176:177], v15 offset:12288
    ds_read_b64_tr_b16 v[178:179], v15 offset:12800
    s_waitcnt lgkmcnt(10)
    v_mfma_f32_32x32x16_bf16 v[112:127], v[184:187], a[104:107], v[112:127]
    s_add_u32 s84, s78, 65536
    buffer_load_dwordx4 a[232:235], v7, s[32:35], s84 offen
    ds_read_b128 v[152:155], v20 offset:64
    buffer_load_dwordx4 a[236:239], v6, s[32:35], s84 offen offset:1024
    ds_read_b64_tr_b16 v[180:181], v15 offset:14336
    ds_read_b64_tr_b16 v[182:183], v15 offset:14848
    s_waitcnt lgkmcnt(11)
    v_mfma_f32_32x32x16_bf16 v[112:127], v[188:191], a[108:111], v[112:127]
    ds_read_b128 v[156:159], v20 offset:96
    s_waitcnt lgkmcnt(9)
    v_mfma_f32_32x32x16_bf16 v[112:127], v[192:195], a[112:115], v[112:127]
    ds_read_b128 v[160:163], v20 offset:128
    ds_read_b128 v[164:167], v20 offset:160
    s_waitcnt lgkmcnt(8)
    v_mfma_f32_32x32x16_bf16 v[112:127], v[196:199], a[116:119], v[112:127]
    ds_read_b128 v[168:171], v20 offset:192
    s_waitcnt lgkmcnt(7)
    v_mfma_f32_32x32x16_bf16 v[112:127], v[176:179], a[120:123], v[112:127]
    ds_read_b128 v[172:175], v20 offset:224
    s_waitcnt lgkmcnt(5)
    v_mfma_f32_32x32x16_bf16 v[112:127], v[180:183], a[124:127], v[112:127]
    buffer_load_dword v249, v250, s[40:43], s8 offen sc1
    s_lshl_b32 s67, s46, 7
    s_add_u32 s67, s67, 0
    v_add_u32 v13, s67, v5
    v_xor_b32 v13, 64, v13
    ds_read_b64_tr_b16 v[176:177], v13 offset:0
    ds_read_b64_tr_b16 v[178:179], v13 offset:512
    ds_read_b64_tr_b16 v[180:181], v13 offset:2048
    ds_read_b64_tr_b16 v[182:183], v13 offset:2560
    ds_read_b64_tr_b16 v[184:185], v13 offset:4096
    ds_read_b64_tr_b16 v[186:187], v13 offset:4608
    ds_read_b64_tr_b16 v[188:189], v13 offset:6144
    ds_read_b64_tr_b16 v[190:191], v13 offset:6656
    ds_read_b64_tr_b16 v[192:193], v13 offset:8192
    ds_read_b64_tr_b16 v[194:195], v13 offset:8704
    s_lshl_b32 s67, s47, 7
    s_add_u32 s67, s67, 0
    v_add_u32 v15, s67, v5
    v_xor_b32 v15, 64, v15
    .p2align 3
    v_pk_fma_f32 v[112:113], v[144:145], v[30:31], v[112:113] op_sel:[0,1,0] op_sel_hi:[1,1,1]
    v_pk_fma_f32 v[114:115], v[146:147], v[30:31], v[114:115] op_sel:[0,1,0] op_sel_hi:[1,1,1]
    v_pk_fma_f32 v[116:117], v[148:149], v[30:31], v[116:117] op_sel:[0,1,0] op_sel_hi:[1,1,1]
    v_pk_fma_f32 v[118:119], v[150:151], v[30:31], v[118:119] op_sel:[0,1,0] op_sel_hi:[1,1,1]
    v_pk_mul_f32 v[224:225], v[112:113], v[112:113]
    v_pk_mul_f32 v[226:227], v[114:115], v[114:115]
    v_pk_mul_f32 v[228:229], v[116:117], v[116:117]
    v_pk_mul_f32 v[230:231], v[118:119], v[118:119]
    v_pk_fma_f32 v[224:225], v[224:225], v[28:29], v[28:29] op_sel:[0,1,0] op_sel_hi:[1,1,0]
    v_pk_fma_f32 v[226:227], v[226:227], v[28:29], v[28:29] op_sel:[0,1,0] op_sel_hi:[1,1,0]
    v_pk_fma_f32 v[228:229], v[228:229], v[28:29], v[28:29] op_sel:[0,1,0] op_sel_hi:[1,1,0]
    v_pk_fma_f32 v[230:231], v[230:231], v[28:29], v[28:29] op_sel:[0,1,0] op_sel_hi:[1,1,0]
    v_pk_mul_f32 v[224:225], v[224:225], v[112:113]
    v_pk_mul_f32 v[226:227], v[226:227], v[114:115]
    v_pk_mul_f32 v[228:229], v[228:229], v[116:117]
    v_pk_mul_f32 v[230:231], v[230:231], v[118:119]
    v_exp_f32 v224, v224
    v_exp_f32 v225, v225
    v_exp_f32 v226, v226
    v_exp_f32 v227, v227
    v_exp_f32 v228, v228
    v_exp_f32 v229, v229
    v_exp_f32 v230, v230
    v_exp_f32 v231, v231
    v_pk_fma_f32 v[224:225], v[224:225], v[30:31], v[30:31] op_sel:[0,0,0] op_sel_hi:[1,0,0]
    v_pk_fma_f32 v[226:227], v[226:227], v[30:31], v[30:31] op_sel:[0,0,0] op_sel_hi:[1,0,0]
    v_pk_fma_f32 v[228:229], v[228:229], v[30:31], v[30:31] op_sel:[0,0,0] op_sel_hi:[1,0,0]
    v_pk_fma_f32 v[230:231], v[230:231], v[30:31], v[30:31] op_sel:[0,0,0] op_sel_hi:[1,0,0]
    v_rcp_f32 v224, v224
    v_rcp_f32 v225, v225
    v_rcp_f32 v226, v226
    v_rcp_f32 v227, v227
    v_rcp_f32 v228, v228
    v_rcp_f32 v229, v229
    v_rcp_f32 v230, v230
    v_rcp_f32 v231, v231
    v_pk_mul_f32 v[224:225], v[224:225], v[112:113]
    v_pk_mul_f32 v[226:227], v[226:227], v[114:115]
    v_pk_mul_f32 v[228:229], v[228:229], v[116:117]
    v_pk_mul_f32 v[230:231], v[230:231], v[118:119]
    v_cvt_pk_bf16_f32 v208, v224, v225
    v_cvt_pk_bf16_f32 v209, v226, v227
    v_cvt_pk_bf16_f32 v210, v228, v229
    v_cvt_pk_bf16_f32 v211, v230, v231
    .p2align 3
    v_pk_fma_f32 v[120:121], v[152:153], v[30:31], v[120:121] op_sel:[0,1,0] op_sel_hi:[1,1,1]
    v_pk_fma_f32 v[122:123], v[154:155], v[30:31], v[122:123] op_sel:[0,1,0] op_sel_hi:[1,1,1]
    s_waitcnt lgkmcnt(14)
    v_pk_fma_f32 v[124:125], v[156:157], v[30:31], v[124:125] op_sel:[0,1,0] op_sel_hi:[1,1,1]
    v_pk_fma_f32 v[126:127], v[158:159], v[30:31], v[126:127] op_sel:[0,1,0] op_sel_hi:[1,1,1]
    v_pk_mul_f32 v[224:225], v[120:121], v[120:121]
    v_pk_mul_f32 v[226:227], v[122:123], v[122:123]
    v_pk_mul_f32 v[228:229], v[124:125], v[124:125]
    v_pk_mul_f32 v[230:231], v[126:127], v[126:127]
    v_pk_fma_f32 v[224:225], v[224:225], v[28:29], v[28:29] op_sel:[0,1,0] op_sel_hi:[1,1,0]
    v_pk_fma_f32 v[226:227], v[226:227], v[28:29], v[28:29] op_sel:[0,1,0] op_sel_hi:[1,1,0]
    v_pk_fma_f32 v[228:229], v[228:229], v[28:29], v[28:29] op_sel:[0,1,0] op_sel_hi:[1,1,0]
    v_pk_fma_f32 v[230:231], v[230:231], v[28:29], v[28:29] op_sel:[0,1,0] op_sel_hi:[1,1,0]
    v_pk_mul_f32 v[224:225], v[224:225], v[120:121]
    v_pk_mul_f32 v[226:227], v[226:227], v[122:123]
    v_pk_mul_f32 v[228:229], v[228:229], v[124:125]
    v_pk_mul_f32 v[230:231], v[230:231], v[126:127]
    v_exp_f32 v224, v224
    v_exp_f32 v225, v225
    v_exp_f32 v226, v226
    v_exp_f32 v227, v227
    v_exp_f32 v228, v228
    v_exp_f32 v229, v229
    v_exp_f32 v230, v230
    v_exp_f32 v231, v231
    v_pk_fma_f32 v[224:225], v[224:225], v[30:31], v[30:31] op_sel:[0,0,0] op_sel_hi:[1,0,0]
    v_pk_fma_f32 v[226:227], v[226:227], v[30:31], v[30:31] op_sel:[0,0,0] op_sel_hi:[1,0,0]
    v_pk_fma_f32 v[228:229], v[228:229], v[30:31], v[30:31] op_sel:[0,0,0] op_sel_hi:[1,0,0]
    v_pk_fma_f32 v[230:231], v[230:231], v[30:31], v[30:31] op_sel:[0,0,0] op_sel_hi:[1,0,0]
    v_rcp_f32 v224, v224
    v_rcp_f32 v225, v225
    v_rcp_f32 v226, v226
    v_rcp_f32 v227, v227
    v_rcp_f32 v228, v228
    v_rcp_f32 v229, v229
    buffer_load_dword v248, v252, s[40:43], s90 offen sc1
    v_rcp_f32 v230, v230
    v_rcp_f32 v231, v231
    v_pk_mul_f32 v[224:225], v[224:225], v[120:121]
    v_pk_mul_f32 v[226:227], v[226:227], v[122:123]
    v_pk_mul_f32 v[228:229], v[228:229], v[124:125]
    v_pk_mul_f32 v[230:231], v[230:231], v[126:127]
    v_cvt_pk_bf16_f32 v212, v224, v225
    v_cvt_pk_bf16_f32 v213, v226, v227
    v_cvt_pk_bf16_f32 v214, v228, v229
    v_cvt_pk_bf16_f32 v215, v230, v231
    buffer_store_dwordx4 v[208:211], v2, s[40:43], s89 offen sc1
    buffer_store_dwordx4 v[212:215], v2, s[40:43], s89 offen offset:2048 sc1
    s_add_u32 s89, s89, 57344
    s_nop 0
    s_waitcnt lgkmcnt(8)
    v_mfma_f32_32x32x16_bf16 v[128:143], v[176:179], a[0:3], 0
    ds_read_b64_tr_b16 v[196:197], v13 offset:10240
    ds_read_b64_tr_b16 v[198:199], v13 offset:10752
    s_waitcnt lgkmcnt(8)
    v_mfma_f32_32x32x16_bf16 v[128:143], v[180:183], a[4:7], v[128:143]
    ds_read_b64_tr_b16 v[176:177], v13 offset:12288
    ds_read_b64_tr_b16 v[178:179], v13 offset:12800
    s_waitcnt lgkmcnt(8)
    v_mfma_f32_32x32x16_bf16 v[128:143], v[184:187], a[8:11], v[128:143]
    ds_read_b64_tr_b16 v[180:181], v13 offset:14336
    ds_read_b64_tr_b16 v[182:183], v13 offset:14848
    s_waitcnt lgkmcnt(8)
    v_mfma_f32_32x32x16_bf16 v[128:143], v[188:191], a[12:15], v[128:143]
    ds_read_b64_tr_b16 v[184:185], v15 offset:0
    ds_read_b64_tr_b16 v[186:187], v15 offset:512
    s_waitcnt lgkmcnt(8)
    v_mfma_f32_32x32x16_bf16 v[128:143], v[192:195], a[16:19], v[128:143]
    ds_read_b64_tr_b16 v[188:189], v15 offset:2048
    ds_read_b64_tr_b16 v[190:191], v15 offset:2560
    s_waitcnt lgkmcnt(8)
    v_mfma_f32_32x32x16_bf16 v[128:143], v[196:199], a[20:23], v[128:143]
    ds_read_b64_tr_b16 v[192:193], v15 offset:4096
    ds_read_b64_tr_b16 v[194:195], v15 offset:4608
    s_waitcnt lgkmcnt(8)
    v_mfma_f32_32x32x16_bf16 v[128:143], v[176:179], a[24:27], v[128:143]
    ds_read_b64_tr_b16 v[196:197], v15 offset:6144
    ds_read_b64_tr_b16 v[198:199], v15 offset:6656
    s_lshl_b32 s67, s3, 7
    s_add_u32 s67, s67, 0
    v_add_u32 v13, s67, v5
    v_xor_b32 v13, 64, v13
    s_waitcnt lgkmcnt(8)
    v_mfma_f32_32x32x16_bf16 v[128:143], v[180:183], a[28:31], v[128:143]
    ds_read_b64_tr_b16 v[176:177], v15 offset:8192
    ds_read_b64_tr_b16 v[178:179], v15 offset:8704
    s_waitcnt lgkmcnt(8)
    v_mfma_f32_32x32x16_bf16 v[128:143], v[184:187], a[32:35], v[128:143]
    ds_read_b64_tr_b16 v[180:181], v15 offset:10240
    ds_read_b64_tr_b16 v[182:183], v15 offset:10752
    s_waitcnt lgkmcnt(8)
    v_mfma_f32_32x32x16_bf16 v[128:143], v[188:191], a[36:39], v[128:143]
    ds_read_b64_tr_b16 v[184:185], v15 offset:12288
    ds_read_b64_tr_b16 v[186:187], v15 offset:12800
    s_waitcnt lgkmcnt(8)
    v_mfma_f32_32x32x16_bf16 v[128:143], v[192:195], a[40:43], v[128:143]
    ds_read_b64_tr_b16 v[188:189], v15 offset:14336
    ds_read_b64_tr_b16 v[190:191], v15 offset:14848
    s_waitcnt lgkmcnt(8)
    v_mfma_f32_32x32x16_bf16 v[128:143], v[196:199], a[44:47], v[128:143]
    ds_read_b64_tr_b16 v[192:193], v13 offset:0
    ds_read_b64_tr_b16 v[194:195], v13 offset:512
    s_waitcnt lgkmcnt(8)
    v_mfma_f32_32x32x16_bf16 v[128:143], v[176:179], a[48:51], v[128:143]
    ds_read_b64_tr_b16 v[196:197], v13 offset:2048
    ds_read_b64_tr_b16 v[198:199], v13 offset:2560
    s_waitcnt lgkmcnt(8)
    v_mfma_f32_32x32x16_bf16 v[128:143], v[180:183], a[52:55], v[128:143]
    s_add_u32 s87, s64, 4
    s_waitcnt vmcnt(2)
    v_subrev_u32 v248, s87, v248
    v_cmp_lt_u32 vcc, 2, v248
    s_cbranch_vccz L_pdone_12
    s_mov_b32 s71, 400000
L_poll_11:
    s_sleep 3
    s_sub_u32 s71, s71, 1
    buffer_load_dword v248, v252, s[40:43], s90 offen sc1
    s_waitcnt vmcnt(0)
    v_subrev_u32 v248, s87, v248
    v_cmp_lt_u32 vcc, 2, v248
    s_cbranch_vccz L_pdone_12
    s_cmp_lg_u32 s71, 0
    s_cbranch_scc1 L_poll_11
L_pdone_12:
    s_nop 0
    s_add_u32 s97, s91, 0
    buffer_load_dwordx4 v[48:51], v10, s[40:43], s97 offen offset:0 sc1
    buffer_load_dwordx4 v[52:55], v11, s[40:43], s97 offen offset:0 sc1
    buffer_load_dwordx4 v[56:59], v10, s[40:43], s97 offen offset:2048 sc1
    buffer_load_dwordx4 v[60:63], v11, s[40:43], s97 offen offset:2048 sc1
    ds_read_b64_tr_b16 v[176:177], v13 offset:4096
    ds_read_b64_tr_b16 v[178:179], v13 offset:4608
    s_waitcnt lgkmcnt(8)
    v_mfma_f32_32x32x16_bf16 v[128:143], v[184:187], a[56:59], v[128:143]
    ds_read_b64_tr_b16 v[180:181], v13 offset:6144
    ds_read_b64_tr_b16 v[182:183], v13 offset:6656
    s_lshl_b32 s67, s95, 7
    s_add_u32 s67, s67, 0
    v_add_u32 v15, s67, v5
    v_xor_b32 v15, 64, v15
    s_add_u32 s97, s91, 4096
    buffer_load_dwordx4 v[64:67], v10, s[40:43], s97 offen offset:0 sc1
    buffer_load_dwordx4 v[68:71], v11, s[40:43], s97 offen offset:0 sc1
    s_waitcnt lgkmcnt(8)
    v_mfma_f32_32x32x16_bf16 v[128:143], v[188:191], a[60:63], v[128:143]
    s_add_u32 s87, s64, 2
    v_subrev_u32 v249, s87, v249
    v_cmp_lt_u32 vcc, 4, v249
    s_cbranch_vccz L_pdone_10
    s_mov_b32 s71, 400000
L_poll_9:
    s_sleep 3
    s_sub_u32 s71, s71, 1
    buffer_load_dword v249, v250, s[40:43], s8 offen sc1
    s_waitcnt vmcnt(0)
    v_subrev_u32 v249, s87, v249
    v_cmp_lt_u32 vcc, 4, v249
    s_cbranch_vccz L_pdone_10
    s_cmp_lg_u32 s71, 0
    s_cbranch_scc1 L_poll_9
L_pdone_10:
    s_mov_b32 m0, s10
    s_nop 0
    buffer_load_dwordx4 v2, s[40:43], s9 offen sc1 lds
    buffer_load_dwordx4 v2, s[40:43], s9 offen offset:1024 sc1 lds
    ds_read_b64_tr_b16 v[184:185], v13 offset:8192
    ds_read_b64_tr_b16 v[186:187], v13 offset:8704
    s_waitcnt lgkmcnt(8)
    v_mfma_f32_32x32x16_bf16 v[128:143], v[192:195], a[64:67], v[128:143]
    ds_read_b64_tr_b16 v[188:189], v13 offset:10240
    ds_read_b64_tr_b16 v[190:191], v13 offset:10752
    s_waitcnt lgkmcnt(8)
    v_mfma_f32_32x32x16_bf16 v[128:143], v[196:199], a[68:71], v[128:143]
    ds_read_b64_tr_b16 v[192:193], v13 offset:12288
    ds_read_b64_tr_b16 v[194:195], v13 offset:12800
    s_waitcnt lgkmcnt(8)
    v_mfma_f32_32x32x16_bf16 v[128:143], v[176:179], a[72:75], v[128:143]
    ds_read_b64_tr_b16 v[196:197], v13 offset:14336
    ds_read_b64_tr_b16 v[198:199], v13 offset:14848
    s_waitcnt lgkmcnt(8)
    v_mfma_f32_32x32x16_bf16 v[128:143], v[180:183], a[76:79], v[128:143]
    ds_read_b64_tr_b16 v[176:177], v15 offset:0
    ds_read_b64_tr_b16 v[178:179], v15 offset:512
    s_waitcnt lgkmcnt(8)
    v_mfma_f32_32x32x16_bf16 v[128:143], v[184:187], a[80:83], v[128:143]
    ds_read_b64_tr_b16 v[180:181], v15 offset:2048
    ds_read_b64_tr_b16 v[182:183], v15 offset:2560
    s_waitcnt lgkmcnt(8)
    v_mfma_f32_32x32x16_bf16 v[128:143], v[188:191], a[84:87], v[128:143]
    ds_read_b64_tr_b16 v[184:185], v15 offset:4096
    ds_read_b64_tr_b16 v[186:187], v15 offset:4608
    s_waitcnt lgkmcnt(8)
    v_mfma_f32_32x32x16_bf16 v[128:143], v[192:195], a[88:91], v[128:143]
    ds_read_b64_tr_b16 v[188:189], v15 offset:6144
    ds_read_b64_tr_b16 v[190:191], v15 offset:6656
    s_waitcnt lgkmcnt(8)
    v_mfma_f32_32x32x16_bf16 v[128:143], v[196:199], a[92:95], v[128:143]
    buffer_load_dwordx4 v[72:75], v10, s[40:43], s97 offen offset:2048 sc1
    ds_read_b64_tr_b16 v[192:193], v15 offset:8192
    buffer_load_dwordx4 v[76:79], v11, s[40:43], s97 offen offset:2048 sc1
    ds_read_b64_tr_b16 v[194:195], v15 offset:8704
    s_waitcnt lgkmcnt(8)
    v_mfma_f32_32x32x16_bf16 v[128:143], v[176:179], a[96:99], v[128:143]
    ds_read_b64_tr_b16 v[196:197], v15 offset:10240
    ds_read_b64_tr_b16 v[198:199], v15 offset:10752
    s_waitcnt lgkmcnt(8)
    v_mfma_f32_32x32x16_bf16 v[128:143], v[180:183], a[100:103], v[128:143]
    ds_read_b64_tr_b16 v[176:177], v15 offset:12288
    ds_read_b64_tr_b16 v[178:179], v15 offset:12800
    s_waitcnt lgkmcnt(8)
    v_mfma_f32_32x32x16_bf16 v[128:143], v[184:187], a[104:107], v[128:143]
    ds_read_b64_tr_b16 v[180:181], v15 offset:14336
    ds_read_b64_tr_b16 v[182:183], v15 offset:14848
    s_waitcnt lgkmcnt(8)
    v_mfma_f32_32x32x16_bf16 v[128:143], v[188:191], a[108:111], v[128:143]
    v_add_u32_e64 v18, s64, 5
    s_waitcnt vmcnt(10)
    s_mov_b64 exec, 1
    buffer_store_dword v18, v255, s[40:43], s79 offen sc1
    s_mov_b64 exec, -1
    s_waitcnt lgkmcnt(6)
    v_mfma_f32_32x32x16_bf16 v[128:143], v[192:195], a[112:115], v[128:143]
    s_waitcnt lgkmcnt(4)
    v_mfma_f32_32x32x16_bf16 v[128:143], v[196:199], a[116:119], v[128:143]
    s_waitcnt lgkmcnt(2)
    v_mfma_f32_32x32x16_bf16 v[128:143], v[176:179], a[120:123], v[128:143]
    s_waitcnt lgkmcnt(0)
    v_mfma_f32_32x32x16_bf16 v[128:143], v[180:183], a[124:127], v[128:143]
    s_waitcnt vmcnt(8)
    s_add_u32 s97, s91, 8192
    buffer_load_dwordx4 v[80:83], v10, s[40:43], s97 offen offset:0 sc1
    buffer_load_dwordx4 v[84:87], v11, s[40:43], s97 offen offset:0 sc1
    s_waitcnt vmcnt(8)
    buffer_load_dwordx4 v[88:91], v10, s[40:43], s97 offen offset:2048 sc1
    buffer_load_dwordx4 v[92:95], v11, s[40:43], s97 offen offset:2048 sc1
    s_waitcnt vmcnt(8)
    s_add_u32 s97, s91, 12288
    buffer_load_dwordx4 v[96:99], v10, s[40:43], s97 offen offset:0 sc1
    buffer_load_dwordx4 v[100:103], v11, s[40:43], s97 offen offset:0 sc1
    s_waitcnt vmcnt(9)
    s_barrier
    v_add_u32 v13, 65536, v3
    v_add_u32 v14, 65536, v4
    v_add_u32 v15, 65536, v12
    ds_read_b64_tr_b16 v[176:177], v13 offset:0
    ds_read_b64_tr_b16 v[178:179], v13 offset:512
    ds_read_b64_tr_b16 v[180:181], v14 offset:0
    ds_read_b64_tr_b16 v[182:183], v14 offset:512
    ds_read_b64_tr_b16 v[184:185], v13 offset:2048
    ds_read_b64_tr_b16 v[186:187], v13 offset:2560
    ds_read_b64_tr_b16 v[188:189], v14 offset:2048
    s_add_u32 s92, s91, 57344
    buffer_load_dwordx4 a[0:3], v10, s[40:43], s92 offen offset:0 sc1
    buffer_load_dwordx4 a[4:7], v11, s[40:43], s92 offen offset:0 sc1
    ds_read_b64_tr_b16 v[190:191], v14 offset:2560
    ds_read_b64_tr_b16 v[192:193], v13 offset:4096
    ds_read_b64_tr_b16 v[194:195], v13 offset:4608
    ds_read_b64_tr_b16 v[196:197], v14 offset:4096
    ds_read_b64_tr_b16 v[198:199], v14 offset:4608
    .p2align 3
    v_pk_fma_f32 v[128:129], v[160:161], v[30:31], v[128:129] op_sel:[0,1,0] op_sel_hi:[1,1,1]
    v_pk_fma_f32 v[130:131], v[162:163], v[30:31], v[130:131] op_sel:[0,1,0] op_sel_hi:[1,1,1]
    v_pk_fma_f32 v[132:133], v[164:165], v[30:31], v[132:133] op_sel:[0,1,0] op_sel_hi:[1,1,1]
    v_pk_fma_f32 v[134:135], v[166:167], v[30:31], v[134:135] op_sel:[0,1,0] op_sel_hi:[1,1,1]
    v_pk_mul_f32 v[224:225], v[128:129], v[128:129]
    v_pk_mul_f32 v[226:227], v[130:131], v[130:131]
    v_pk_mul_f32 v[228:229], v[132:133], v[132:133]
    v_pk_mul_f32 v[230:231], v[134:135], v[134:135]
    v_pk_fma_f32 v[224:225], v[224:225], v[28:29], v[28:29] op_sel:[0,1,0] op_sel_hi:[1,1,0]
    v_pk_fma_f32 v[226:227], v[226:227], v[28:29], v[28:29] op_sel:[0,1,0] op_sel_hi:[1,1,0]
    v_pk_fma_f32 v[228:229], v[228:229], v[28:29], v[28:29] op_sel:[0,1,0] op_sel_hi:[1,1,0]
    v_pk_fma_f32 v[230:231], v[230:231], v[28:29], v[28:29] op_sel:[0,1,0] op_sel_hi:[1,1,0]
    v_pk_mul_f32 v[224:225], v[224:225], v[128:129]
    v_pk_mul_f32 v[226:227], v[226:227], v[130:131]
    v_pk_mul_f32 v[228:229], v[228:229], v[132:133]
    v_pk_mul_f32 v[230:231], v[230:231], v[134:135]
    v_exp_f32 v224, v224
    v_exp_f32 v225, v225
    v_exp_f32 v226, v226
    v_exp_f32 v227, v227
    v_exp_f32 v228, v228
    v_exp_f32 v229, v229
    buffer_load_dwordx4 a[8:11], v10, s[40:43], s92 offen offset:2048 sc1
    buffer_load_dwordx4 a[12:15], v11, s[40:43], s92 offen offset:2048 sc1
    v_exp_f32 v230, v230
    v_exp_f32 v231, v231
    v_pk_fma_f32 v[224:225], v[224:225], v[30:31], v[30:31] op_sel:[0,0,0] op_sel_hi:[1,0,0]
    v_pk_fma_f32 v[226:227], v[226:227], v[30:31], v[30:31] op_sel:[0,0,0] op_sel_hi:[1,0,0]
    v_pk_fma_f32 v[228:229], v[228:229], v[30:31], v[30:31] op_sel:[0,0,0] op_sel_hi:[1,0,0]
    v_pk_fma_f32 v[230:231], v[230:231], v[30:31], v[30:31] op_sel:[0,0,0] op_sel_hi:[1,0,0]
    v_rcp_f32 v224, v224
    v_rcp_f32 v225, v225
    v_rcp_f32 v226, v226
    v_rcp_f32 v227, v227
    v_rcp_f32 v228, v228
    v_rcp_f32 v229, v229
    v_rcp_f32 v230, v230
    v_rcp_f32 v231, v231
    v_pk_mul_f32 v[224:225], v[224:225], v[128:129]
    v_pk_mul_f32 v[226:227], v[226:227], v[130:131]
    v_pk_mul_f32 v[228:229], v[228:229], v[132:133]
    v_pk_mul_f32 v[230:231], v[230:231], v[134:135]
    v_cvt_pk_bf16_f32 v216, v224, v225
    v_cvt_pk_bf16_f32 v217, v226, v227
    v_cvt_pk_bf16_f32 v218, v228, v229
    v_cvt_pk_bf16_f32 v219, v230, v231
    .p2align 3
    v_pk_fma_f32 v[136:137], v[168:169], v[30:31], v[136:137] op_sel:[0,1,0] op_sel_hi:[1,1,1]
    v_pk_fma_f32 v[138:139], v[170:171], v[30:31], v[138:139] op_sel:[0,1,0] op_sel_hi:[1,1,1]
    v_pk_fma_f32 v[140:141], v[172:173], v[30:31], v[140:141] op_sel:[0,1,0] op_sel_hi:[1,1,1]
    v_pk_fma_f32 v[142:143], v[174:175], v[30:31], v[142:143] op_sel:[0,1,0] op_sel_hi:[1,1,1]
    v_pk_mul_f32 v[224:225], v[136:137], v[136:137]
    v_pk_mul_f32 v[226:227], v[138:139], v[138:139]
    v_pk_mul_f32 v[228:229], v[140:141], v[140:141]
    v_pk_mul_f32 v[230:231], v[142:143], v[142:143]
    v_pk_fma_f32 v[224:225], v[224:225], v[28:29], v[28:29] op_sel:[0,1,0] op_sel_hi:[1,1,0]
    v_pk_fma_f32 v[226:227], v[226:227], v[28:29], v[28:29] op_sel:[0,1,0] op_sel_hi:[1,1,0]
    v_pk_fma_f32 v[228:229], v[228:229], v[28:29], v[28:29] op_sel:[0,1,0] op_sel_hi:[1,1,0]
    v_pk_fma_f32 v[230:231], v[230:231], v[28:29], v[28:29] op_sel:[0,1,0] op_sel_hi:[1,1,0]
    v_pk_mul_f32 v[224:225], v[224:225], v[136:137]
    v_pk_mul_f32 v[226:227], v[226:227], v[138:139]
    s_add_u32 s92, s91, 61440
    buffer_load_dwordx4 a[16:19], v10, s[40:43], s92 offen offset:0 sc1
    buffer_load_dwordx4 a[20:23], v11, s[40:43], s92 offen offset:0 sc1
    v_pk_mul_f32 v[228:229], v[228:229], v[140:141]
    v_pk_mul_f32 v[230:231], v[230:231], v[142:143]
    v_exp_f32 v224, v224
    v_exp_f32 v225, v225
    v_exp_f32 v226, v226
    v_exp_f32 v227, v227
    v_exp_f32 v228, v228
    v_exp_f32 v229, v229
    v_exp_f32 v230, v230
    v_exp_f32 v231, v231
    v_pk_fma_f32 v[224:225], v[224:225], v[30:31], v[30:31] op_sel:[0,0,0] op_sel_hi:[1,0,0]
    v_pk_fma_f32 v[226:227], v[226:227], v[30:31], v[30:31] op_sel:[0,0,0] op_sel_hi:[1,0,0]
    v_pk_fma_f32 v[228:229], v[228:229], v[30:31], v[30:31] op_sel:[0,0,0] op_sel_hi:[1,0,0]
    v_pk_fma_f32 v[230:231], v[230:231], v[30:31], v[30:31] op_sel:[0,0,0] op_sel_hi:[1,0,0]
    v_rcp_f32 v224, v224
    v_rcp_f32 v225, v225
    v_rcp_f32 v226, v226
    v_rcp_f32 v227, v227
    v_rcp_f32 v228, v228
    v_rcp_f32 v229, v229
    v_rcp_f32 v230, v230
    v_rcp_f32 v231, v231
    v_pk_mul_f32 v[224:225], v[224:225], v[136:137]
    buffer_load_dwordx4 a[24:27], v10, s[40:43], s92 offen offset:2048 sc1
    buffer_load_dwordx4 a[28:31], v11, s[40:43], s92 offen offset:2048 sc1
    v_pk_mul_f32 v[226:227], v[226:227], v[138:139]
    v_pk_mul_f32 v[228:229], v[228:229], v[140:141]
    v_pk_mul_f32 v[230:231], v[230:231], v[142:143]
    v_cvt_pk_bf16_f32 v220, v224, v225
    v_cvt_pk_bf16_f32 v221, v226, v227
    v_cvt_pk_bf16_f32 v222, v228, v229
    v_cvt_pk_bf16_f32 v223, v230, v231
    buffer_store_dwordx4 v[216:219], v2, s[40:43], s89 offen sc1
    buffer_store_dwordx4 v[220:223], v2, s[40:43], s89 offen offset:2048 sc1
    s_add_u32 s89, s89, 57344
    s_nop 0
    buffer_load_dword v248, v252, s[40:43], s90 offen sc1
    s_waitcnt lgkmcnt(10)
    v_mfma_f32_32x32x16_bf16 v[112:127], v[176:179], v[48:51], 0
    ds_read_b64_tr_b16 v[200:201], v13 offset:6144
    ds_read_b64_tr_b16 v[202:203], v13 offset:6656
    s_waitcnt lgkmcnt(10)
    v_mfma_f32_32x32x16_bf16 v[128:143], v[180:183], v[48:51], 0
    ds_read_b64_tr_b16 v[204:205], v14 offset:6144
    ds_read_b64_tr_b16 v[206:207], v14 offset:6656
    v_mfma_f32_32x32x16_bf16 v[144:159], v[176:179], v[52:55], 0
    ds_write_b128 v15, a[128:131] offset:0
    v_mfma_f32_32x32x16_bf16 v[160:175], v[180:183], v[52:55], 0
    ds_write_b128 v15, a[132:135] offset:1024
    s_waitcnt lgkmcnt(12)
    v_mfma_f32_32x32x16_bf16 v[112:127], v[184:187], v[56:59], v[112:127]
    ds_read_b64_tr_b16 v[176:177], v13 offset:8192
    ds_read_b64_tr_b16 v[178:179], v13 offset:8704
    s_waitcnt lgkmcnt(12)
    v_mfma_f32_32x32x16_bf16 v[128:143], v[188:191], v[56:59], v[128:143]
    ds_read_b64_tr_b16 v[180:181], v14 offset:8192
    ds_read_b64_tr_b16 v[182:183], v14 offset:8704
    v_mfma_f32_32x32x16_bf16 v[144:159], v[184:187], v[60:63], v[144:159]
    ds_write_b128 v15, a[136:139] offset:2048
    v_mfma_f32_32x32x16_bf16 v[160:175], v[188:191], v[60:63], v[160:175]
    ds_write_b128 v15, a[140:143] offset:3072
    s_waitcnt lgkmcnt(14)
    v_mfma_f32_32x32x16_bf16 v[112:127], v[192:195], v[64:67], v[112:127]
    s_add_u32 s92, s91, 65536
    buffer_load_dwordx4 a[32:35], v10, s[40:43], s92 offen offset:0 sc1
    ds_read_b64_tr_b16 v[184:185], v13 offset:10240
    buffer_load_dwordx4 a[36:39], v11, s[40:43], s92 offen offset:0 sc1
    ds_read_b64_tr_b16 v[186:187], v13 offset:10752
    s_waitcnt lgkmcnt(14)
    v_mfma_f32_32x32x16_bf16 v[128:143], v[196:199], v[64:67], v[128:143]
    ds_read_b64_tr_b16 v[188:189], v14 offset:10240
    ds_read_b64_tr_b16 v[190:191], v14 offset:10752
    v_mfma_f32_32x32x16_bf16 v[144:159], v[192:195], v[68:71], v[144:159]
    ds_write_b128 v15, a[144:147] offset:4096
    v_mfma_f32_32x32x16_bf16 v[160:175], v[196:199], v[68:71], v[160:175]
    ds_write_b128 v15, a[148:151] offset:5120
    s_waitcnt vmcnt(21) lgkmcnt(15)
    v_mfma_f32_32x32x16_bf16 v[112:127], v[200:203], v[72:75], v[112:127]
    ds_read_b64_tr_b16 v[192:193], v13 offset:12288
    ds_read_b64_tr_b16 v[194:195], v13 offset:12800
    s_waitcnt lgkmcnt(15)
    v_mfma_f32_32x32x16_bf16 v[128:143], v[204:207], v[72:75], v[128:143]
    ds_read_b64_tr_b16 v[196:197], v14 offset:12288
    ds_read_b64_tr_b16 v[198:199], v14 offset:12800
    s_waitcnt vmcnt(20)
    v_mfma_f32_32x32x16_bf16 v[144:159], v[200:203], v[76:79], v[144:159]
    buffer_load_dwordx4 a[40:43], v10, s[40:43], s92 offen offset:2048 sc1
    ds_write_b128 v15, a[152:155] offset:6144
    buffer_load_dwordx4 a[44:47], v11, s[40:43], s92 offen offset:2048 sc1
    v_mfma_f32_32x32x16_bf16 v[160:175], v[204:207], v[76:79], v[160:175]
    s_waitcnt vmcnt(8)
    s_add_u32 s92, s91, 69632
    buffer_load_dwordx4 a[48:51], v10, s[40:43], s92 offen offset:0 sc1
    buffer_load_dwordx4 a[52:55], v11, s[40:43], s92 offen offset:0 sc1
    s_waitcnt vmcnt(8)
    s_add_u32 m0, s80, 0
    s_add_u32 s84, s72, 98304
    buffer_load_dwordx4 v7, s[32:35], s84 offen  lds
    buffer_load_dwordx4 v6, s[32:35], s84 offen offset:1024  lds
    s_add_u32 s87, s64, 5
    s_waitcnt vmcnt(8)
    v_subrev_u32 v248, s87, v248
    v_cmp_lt_u32 vcc, 1, v248
    s_cbranch_vccz L_pdone_14
    s_mov_b32 s71, 400000
L_poll_13:
    s_sleep 3
    s_sub_u32 s71, s71, 1
    buffer_load_dword v248, v252, s[40:43], s90 offen sc1
    s_waitcnt vmcnt(0)
    v_subrev_u32 v248, s87, v248
    v_cmp_lt_u32 vcc, 1, v248
    s_cbranch_vccz L_pdone_14
    s_cmp_lg_u32 s71, 0
    s_cbranch_scc1 L_poll_13
L_pdone_14:
    ds_write_b128 v15, a[156:159] offset:7168
    s_add_u32 s97, s91, 114688
    buffer_load_dwordx4 a[56:59], v10, s[40:43], s97 offen offset:0 sc1
    buffer_load_dwordx4 a[60:63], v11, s[40:43], s97 offen offset:0 sc1
    s_waitcnt lgkmcnt(15)
    v_mfma_f32_32x32x16_bf16 v[112:127], v[176:179], v[80:83], v[112:127]
    ds_read_b64_tr_b16 v[200:201], v13 offset:0
    ds_read_b64_tr_b16 v[202:203], v13 offset:512
    s_waitcnt lgkmcnt(15)
    v_mfma_f32_32x32x16_bf16 v[128:143], v[180:183], v[80:83], v[128:143]
    v_add_u32_e64 v18, s64, 6
    s_mov_b64 exec, 1
    buffer_store_dword v18, v255, s[40:43], s79 offen sc1
    s_mov_b64 exec, -1
    ds_read_b64_tr_b16 v[204:205], v14 offset:0
    ds_read_b64_tr_b16 v[206:207], v14 offset:512
    v_mfma_f32_32x32x16_bf16 v[144:159], v[176:179], v[84:87], v[144:159]
    ds_write_b128 v15, a[160:163] offset:8192
    v_mfma_f32_32x32x16_bf16 v[160:175], v[180:183], v[84:87], v[160:175]
    ds_write_b128 v15, a[164:167] offset:9216
    s_waitcnt lgkmcnt(15)
    v_mfma_f32_32x32x16_bf16 v[112:127], v[184:187], v[88:91], v[112:127]
    ds_read_b64_tr_b16 v[176:177], v13 offset:2048
    ds_read_b64_tr_b16 v[178:179], v13 offset:2560
    s_waitcnt lgkmcnt(15)
    v_mfma_f32_32x32x16_bf16 v[128:143], v[188:191], v[88:91], v[128:143]
    ds_read_b64_tr_b16 v[180:181], v14 offset:2048
    ds_read_b64_tr_b16 v[182:183], v14 offset:2560
    v_mfma_f32_32x32x16_bf16 v[144:159], v[184:187], v[92:95], v[144:159]
    ds_write_b128 v15, a[168:171] offset:10240
    v_mfma_f32_32x32x16_bf16 v[160:175], v[188:191], v[92:95], v[160:175]
    ds_write_b128 v15, a[172:175] offset:11264
    s_waitcnt lgkmcnt(15)
    v_mfma_f32_32x32x16_bf16 v[112:127], v[192:195], v[96:99], v[112:127]
    buffer_load_dwordx4 a[64:67], v10, s[40:43], s97 offen offset:2048 sc1
    ds_read_b64_tr_b16 v[184:185], v13 offset:4096
    buffer_load_dwordx4 a[68:71], v11, s[40:43], s97 offen offset:2048 sc1
    ds_read_b64_tr_b16 v[186:187], v13 offset:4608
    s_waitcnt lgkmcnt(15)
    v_mfma_f32_32x32x16_bf16 v[128:143], v[196:199], v[96:99], v[128:143]
    ds_read_b64_tr_b16 v[188:189], v14 offset:4096
    ds_read_b64_tr_b16 v[190:191], v14 offset:4608
    v_mfma_f32_32x32x16_bf16 v[144:159], v[192:195], v[100:103], v[144:159]
    ds_write_b128 v15, a[176:179] offset:12288
    v_mfma_f32_32x32x16_bf16 v[160:175], v[196:199], v[100:103], v[160:175]
    ds_write_b128 v15, a[180:183] offset:13312
    s_waitcnt lgkmcnt(15)
    v_mfma_f32_32x32x16_bf16 v[112:127], v[200:203], a[0:3], v[112:127]
    ds_read_b64_tr_b16 v[192:193], v13 offset:6144
    ds_read_b64_tr_b16 v[194:195], v13 offset:6656
    s_waitcnt lgkmcnt(15)
    v_mfma_f32_32x32x16_bf16 v[128:143], v[204:207], a[0:3], v[128:143]
    buffer_load_dword v104, v22, s[40:43], s11 offen offset:0 sc1
    ds_read_b64_tr_b16 v[196:197], v14 offset:6144
    ds_read_b64_tr_b16 v[198:199], v14 offset:6656
    v_mfma_f32_32x32x16_bf16 v[144:159], v[200:203], a[4:7], v[144:159]
    ds_write_b128 v15, a[184:187] offset:0
    v_mfma_f32_32x32x16_bf16 v[160:175], v[204:207], a[4:7], v[160:175]
    buffer_load_dword v105, v22, s[40:43], s11 offen offset:256 sc1
    ds_write_b128 v15, a[188:191] offset:1024
    s_waitcnt lgkmcnt(15)
    v_mfma_f32_32x32x16_bf16 v[112:127], v[176:179], a[8:11], v[112:127]
    ds_read_b64_tr_b16 v[200:201], v13 offset:8192
    ds_read_b64_tr_b16 v[202:203], v13 offset:8704
    s_waitcnt lgkmcnt(15)
    v_mfma_f32_32x32x16_bf16 v[128:143], v[180:183], a[8:11], v[128:143]
    s_add_u32 s97, s91, 118784
    buffer_load_dwordx4 a[72:75], v10, s[40:43], s97 offen offset:0 sc1
    buffer_load_dword v106, v22, s[40:43], s11 offen offset:512 sc1
    buffer_load_dwordx4 a[76:79], v11, s[40:43], s97 offen offset:0 sc1
    ds_read_b64_tr_b16 v[204:205], v14 offset:8192
    ds_read_b64_tr_b16 v[206:207], v14 offset:8704
    v_mfma_f32_32x32x16_bf16 v[144:159], v[176:179], a[12:15], v[144:159]
    ds_write_b128 v15, a[192:195] offset:2048
    v_mfma_f32_32x32x16_bf16 v[160:175], v[180:183], a[12:15], v[160:175]
    buffer_load_dword v107, v22, s[40:43], s11 offen offset:768 sc1
    ds_write_b128 v15, a[196:199] offset:3072
    s_waitcnt lgkmcnt(15)
    v_mfma_f32_32x32x16_bf16 v[112:127], v[184:187], a[16:19], v[112:127]
    ds_read_b64_tr_b16 v[176:177], v13 offset:10240
    ds_read_b64_tr_b16 v[178:179], v13 offset:10752
    s_waitcnt lgkmcnt(15)
    v_mfma_f32_32x32x16_bf16 v[128:143], v[188:191], a[16:19], v[128:143]
    buffer_load_dword v108, v22, s[40:43], s11 offen offset:1024 sc1
    ds_read_b64_tr_b16 v[180:181], v14 offset:10240
    ds_read_b64_tr_b16 v[182:183], v14 offset:10752
    v_mfma_f32_32x32x16_bf16 v[144:159], v[184:187], a[20:23], v[144:159]
    ds_write_b128 v15, a[200:203] offset:4096
    v_mfma_f32_32x32x16_bf16 v[160:175], v[188:191], a[20:23], v[160:175]
    buffer_load_dword v109, v22, s[40:43], s11 offen offset:1280 sc1
    ds_write_b128 v15, a[204:207] offset:5120
    s_waitcnt lgkmcnt(15)
    v_mfma_f32_32x32x16_bf16 v[112:127], v[192:195], a[24:27], v[112:127]
    ds_read_b64_tr_b16 v[184:185], v13 offset:12288
    ds_read_b64_tr_b16 v[186:187], v13 offset:12800
    s_waitcnt lgkmcnt(15)
    v_mfma_f32_32x32x16_bf16 v[128:143], v[196:199], a[24:27], v[128:143]
    buffer_load_dword v110, v22, s[40:43], s11 offen offset:1536 sc1
    ds_read_b64_tr_b16 v[188:189], v14 offset:12288
    ds_read_b64_tr_b16 v[190:191], v14 offset:12800
    v_mfma_f32_32x32x16_bf16 v[144:159], v[192:195], a[28:31], v[144:159]
    ds_write_b128 v15, a[208:211] offset:6144
    v_mfma_f32_32x32x16_bf16 v[160:175], v[196:199], a[28:31], v[160:175]
    buffer_load_dword v111, v22, s[40:43], s11 offen offset:1792 sc1
    ds_write_b128 v15, a[212:215] offset:7168
    s_waitcnt vmcnt(22) lgkmcnt(15)
    v_mfma_f32_32x32x16_bf16 v[112:127], v[200:203], a[32:35], v[112:127]
    ds_read_b64_tr_b16 v[192:193], v13 offset:0
    ds_read_b64_tr_b16 v[194:195], v13 offset:512
    s_waitcnt lgkmcnt(15)
    v_mfma_f32_32x32x16_bf16 v[128:143], v[204:207], a[32:35], v[128:143]
    buffer_load_dwordx4 a[80:83], v10, s[40:43], s97 offen offset:2048 sc1
    ds_read_b64_tr_b16 v[196:197], v14 offset:0
    buffer_load_dwordx4 a[84:87], v11, s[40:43], s97 offen offset:2048 sc1
    ds_read_b64_tr_b16 v[198:199], v14 offset:512
    s_waitcnt vmcnt(23)
    v_mfma_f32_32x32x16_bf16 v[144:159], v[200:203], a[36:39], v[144:159]
    ds_write_b128 v15, a[216:219] offset:8192
    v_mfma_f32_32x32x16_bf16 v[160:175], v[204:207], a[36:39], v[160:175]
    ds_write_b128 v15, a[220:223] offset:9216
    s_waitcnt vmcnt(22) lgkmcnt(15)
    v_mfma_f32_32x32x16_bf16 v[112:127], v[176:179], a[40:43], v[112:127]
    s_add_u32 s97, s91, 122880
    buffer_load_dwordx4 a[88:91], v10, s[40:43], s97 offen offset:0 sc1
    ds_read_b64_tr_b16 v[200:201], v13 offset:2048
    buffer_load_dwordx4 a[92:95], v11, s[40:43], s97 offen offset:0 sc1
    ds_read_b64_tr_b16 v[202:203], v13 offset:2560
    s_waitcnt lgkmcnt(15)
    v_mfma_f32_32x32x16_bf16 v[128:143], v[180:183], a[40:43], v[128:143]
    ds_read_b64_tr_b16 v[204:205], v14 offset:2048
    ds_read_b64_tr_b16 v[206:207], v14 offset:2560
    s_waitcnt vmcnt(23)
    v_mfma_f32_32x32x16_bf16 v[144:159], v[176:179], a[44:47], v[144:159]
    ds_write_b128 v15, a[224:227] offset:10240
    v_mfma_f32_32x32x16_bf16 v[160:175], v[180:183], a[44:47], v[160:175]
    buffer_load_dword v248, v252, s[40:43], s90 offen sc1
    ds_write_b128 v15, a[228:231] offset:11264
    s_waitcnt vmcnt(23) lgkmcnt(15)
    v_mfma_f32_32x32x16_bf16 v[112:127], v[184:187], a[48:51], v[112:127]
    ds_read_b64_tr_b16 v[176:177], v13 offset:4096
    ds_read_b64_tr_b16 v[178:179], v13 offset:4608
    s_waitcnt lgkmcnt(15)
    v_mfma_f32_32x32x16_bf16 v[128:143], v[188:191], a[48:51], v[128:143]
    ds_read_b64_tr_b16 v[180:181], v14 offset:4096
    ds_read_b64_tr_b16 v[182:183], v14 offset:4608
    s_waitcnt vmcnt(22)
    v_mfma_f32_32x32x16_bf16 v[144:159], v[184:187], a[52:55], v[144:159]
    ds_write_b128 v15, a[232:235] offset:12288
    v_mfma_f32_32x32x16_bf16 v[160:175], v[188:191], a[52:55], v[160:175]
    ds_write_b128 v15, a[236:239] offset:13312
    s_waitcnt vmcnt(19) lgkmcnt(15)
    v_mfma_f32_32x32x16_bf16 v[112:127], v[192:195], a[56:59], v[112:127]
    ds_read_b64_tr_b16 v[184:185], v13 offset:6144
    ds_read_b64_tr_b16 v[186:187], v13 offset:6656
    s_waitcnt lgkmcnt(15)
    v_mfma_f32_32x32x16_bf16 v[128:143], v[196:199], a[56:59], v[128:143]
    ds_read_b64_tr_b16 v[188:189], v14 offset:6144
    ds_read_b64_tr_b16 v[190:191], v14 offset:6656
    s_waitcnt vmcnt(18)
    v_mfma_f32_32x32x16_bf16 v[144:159], v[192:195], a[60:63], v[144:159]
    buffer_load_dwordx4 a[96:99], v10, s[40:43], s97 offen offset:2048 sc1
    v_mfma_f32_32x32x16_bf16 v[160:175], v[196:199], a[60:63], v[160:175]
    buffer_load_dwordx4 a[100:103], v11, s[40:43], s97 offen offset:2048 sc1
    ds_read_b64_tr_b16 v[208:209], v9 offset:0
    ds_read_b64_tr_b16 v[210:211], v9 offset:512
    ds_read_b64_tr_b16 v[212:213], v9 offset:2048
    ds_read_b64_tr_b16 v[214:215], v9 offset:2560
    s_waitcnt vmcnt(15)
    v_add_f32 v104, v104, v105
    s_waitcnt lgkmcnt(15)
    v_mfma_f32_32x32x16_bf16 v[112:127], v[200:203], a[64:67], v[112:127]
    s_waitcnt vmcnt(13)
    v_add_f32 v104, v104, v106
    s_waitcnt vmcnt(11)
    v_add_f32 v104, v104, v107
    s_add_u32 s97, s91, 126976
    buffer_load_dwordx4 a[104:107], v10, s[40:43], s97 offen offset:0 sc1
    buffer_load_dwordx4 a[108:111], v11, s[40:43], s97 offen offset:0 sc1
    ds_read_b64_tr_b16 v[192:193], v13 offset:8192
    ds_read_b64_tr_b16 v[194:195], v13 offset:8704
    v_mfma_f32_32x32x16_bf16 v[128:143], v[204:207], a[64:67], v[128:143]
    s_waitcnt vmcnt(12)
    v_add_f32 v104, v104, v108
    s_waitcnt vmcnt(11)
    v_add_f32 v104, v104, v109
    s_waitcnt vmcnt(10)
    v_add_f32 v104, v104, v110
    ds_read_b64_tr_b16 v[196:197], v14 offset:8192
    ds_read_b64_tr_b16 v[198:199], v14 offset:8704
    v_mfma_f32_32x32x16_bf16 v[144:159], v[200:203], a[68:71], v[144:159]
    s_waitcnt vmcnt(9)
    v_add_f32 v104, v104, v111
    v_mov_b32 v105, v104
    s_nop 1
    v_permlane32_swap_b32 v104, v105
    v_add_f32 v104, v104, v105
    v_mul_f32 v104, 0xbfb8aa3b, v104
    v_mfma_f32_32x32x16_bf16 v[160:175], v[204:207], a[68:71], v[160:175]
    v_exp_f32 v104, v104
    s_nop 0
    v_add_f32 v104, 1.0, v104
    v_rcp_f32 v28, v104
    s_waitcnt lgkmcnt(15)
    v_mfma_f32_32x32x16_bf16 v[112:127], v[176:179], a[72:75], v[112:127]
    v_sub_f32 v29, 1.0, v28
    s_waitcnt lgkmcnt(7)
    v_lshlrev_b32 v104, 16, v208
    ds_read_b64_tr_b16 v[200:201], v13 offset:10240
    ds_read_b64_tr_b16 v[202:203], v13 offset:10752
    v_mfma_f32_32x32x16_bf16 v[128:143], v[180:183], a[72:75], v[128:143]
    v_lshlrev_b32 v105, 16, v32
    v_lshlrev_b32 v224, 16, v40
    v_mul_f32 v104, v104, v105
    ds_read_b64_tr_b16 v[204:205], v14 offset:10240
    ds_read_b64_tr_b16 v[206:207], v14 offset:10752
    v_mfma_f32_32x32x16_bf16 v[144:159], v[176:179], a[76:79], v[144:159]
    v_mul_f32 v224, v224, v29
    v_fmac_f32 v224, v104, v28
    v_and_b32 v106, s66, v208
    v_and_b32 v107, s66, v32
    v_and_b32 v225, s66, v40
    v_mfma_f32_32x32x16_bf16 v[160:175], v[180:183], a[76:79], v[160:175]
    s_waitcnt vmcnt(8)
    s_add_u32 m0, s80, 2048
    s_add_u32 s84, s73, 98304
    buffer_load_dwordx4 v7, s[32:35], s84 offen  lds
    buffer_load_dwordx4 v6, s[32:35], s84 offen offset:1024  lds
    s_waitcnt vmcnt(8)
    s_add_u32 m0, s80, 4096
    s_add_u32 s84, s74, 98304
    buffer_load_dwordx4 v7, s[32:35], s84 offen  lds
    buffer_load_dwordx4 v6, s[32:35], s84 offen offset:1024  lds
    s_add_u32 s87, s64, 6
    s_waitcnt vmcnt(8)
    v_subrev_u32 v248, s87, v248
    v_cmp_lt_u32 vcc, 0, v248
    s_cbranch_vccz L_pdone_16
    s_mov_b32 s71, 400000
L_poll_15:
    s_sleep 3
    s_sub_u32 s71, s71, 1
    buffer_load_dword v248, v252, s[40:43], s90 offen sc1
    s_waitcnt vmcnt(0)
    v_subrev_u32 v248, s87, v248
    v_cmp_lt_u32 vcc, 0, v248
    s_cbranch_vccz L_pdone_16
    s_cmp_lg_u32 s71, 0
    s_cbranch_scc1 L_poll_15
L_pdone_16:
    s_add_u32 m0, s80, 6144
    s_add_u32 s84, s75, 98304
    buffer_load_dwordx4 v7, s[32:35], s84 offen  lds
    buffer_load_dwordx4 v6, s[32:35], s84 offen offset:1024  lds
    v_mfma_f32_32x32x16_bf16 v[112:127], v[184:187], a[80:83], v[112:127]
    v_mul_f32 v106, v106, v107
    v_mul_f32 v225, v225, v29
    v_fmac_f32 v225, v106, v28
    ds_read_b64_tr_b16 v[176:177], v13 offset:12288
    ds_read_b64_tr_b16 v[178:179], v13 offset:12800
    v_mfma_f32_32x32x16_bf16 v[128:143], v[188:191], a[80:83], v[128:143]
    v_lshlrev_b32 v104, 16, v209
    v_lshlrev_b32 v105, 16, v33
    ds_read_b64_tr_b16 v[180:181], v14 offset:12288
    ds_read_b64_tr_b16 v[182:183], v14 offset:12800
    v_mfma_f32_32x32x16_bf16 v[144:159], v[184:187], a[84:87], v[144:159]
    v_lshlrev_b32 v226, 16, v41
    v_mul_f32 v104, v104, v105
    v_mul_f32 v226, v226, v29
    v_fmac_f32 v226, v104, v28
    v_and_b32 v106, s66, v209
    v_mfma_f32_32x32x16_bf16 v[160:175], v[188:191], a[84:87], v[160:175]
    v_and_b32 v107, s66, v33
    v_and_b32 v227, s66, v41
    v_mul_f32 v106, v106, v107
    v_mul_f32 v227, v227, v29
    v_fmac_f32 v227, v106, v28
    s_waitcnt lgkmcnt(10)
    v_mfma_f32_32x32x16_bf16 v[112:127], v[192:195], a[88:91], v[112:127]
    v_lshlrev_b32 v104, 16, v210
    v_lshlrev_b32 v105, 16, v34
    ds_read_b64_tr_b16 v[184:185], v3 offset:0
    ds_read_b64_tr_b16 v[186:187], v3 offset:512
    s_waitcnt lgkmcnt(10)
    v_mfma_f32_32x32x16_bf16 v[128:143], v[196:199], a[88:91], v[128:143]
    v_lshlrev_b32 v228, 16, v42
    v_mul_f32 v104, v104, v105
    ds_read_b64_tr_b16 v[188:189], v4 offset:0
    ds_read_b64_tr_b16 v[190:191], v4 offset:512
    v_mfma_f32_32x32x16_bf16 v[144:159], v[192:195], a[92:95], v[144:159]
    s_add_u32 m0, s80, 8192
    s_add_u32 s84, s76, 98304
    v_mul_f32 v228, v228, v29
    v_fmac_f32 v228, v104, v28
    v_and_b32 v106, s66, v210
    v_and_b32 v107, s66, v34
    buffer_load_dwordx4 v7, s[32:35], s84 offen  lds
    v_and_b32 v229, s66, v42
    buffer_load_dwordx4 v6, s[32:35], s84 offen offset:1024  lds
    v_mfma_f32_32x32x16_bf16 v[160:175], v[196:199], a[92:95], v[160:175]
    v_mul_f32 v106, v106, v107
    v_mul_f32 v229, v229, v29
    v_fmac_f32 v229, v106, v28
    v_lshlrev_b32 v104, 16, v211
    v_lshlrev_b32 v105, 16, v35
    s_waitcnt vmcnt(11) lgkmcnt(10)
    v_mfma_f32_32x32x16_bf16 v[112:127], v[200:203], a[96:99], v[112:127]
    v_lshlrev_b32 v230, 16, v43
    s_waitcnt vmcnt(8)
    s_add_u32 m0, s80, 10240
    s_add_u32 s84, s77, 98304
    buffer_load_dwordx4 v7, s[32:35], s84 offen  lds
    buffer_load_dwordx4 v6, s[32:35], s84 offen offset:1024  lds
    s_waitcnt vmcnt(8)
    ds_read_b64_tr_b16 v[192:193], v3 offset:2048
    s_add_u32 m0, s80, 12288
    s_add_u32 s84, s78, 98304
    buffer_load_dwordx4 v7, s[32:35], s84 offen  lds
    buffer_load_dwordx4 v6, s[32:35], s84 offen offset:1024  lds
    ds_read_b64_tr_b16 v[194:195], v3 offset:2560
    s_waitcnt lgkmcnt(10)
    v_mfma_f32_32x32x16_bf16 v[128:143], v[204:207], a[96:99], v[128:143]
    v_mul_f32 v104, v104, v105
    v_mul_f32 v230, v230, v29
    v_fmac_f32 v230, v104, v28
    ds_read_b64_tr_b16 v[196:197], v4 offset:2048
    ds_read_b64_tr_b16 v[198:199], v4 offset:2560
    v_mfma_f32_32x32x16_bf16 v[144:159], v[200:203], a[100:103], v[144:159]
    v_and_b32 v106, s66, v211
    v_and_b32 v107, s66, v35
    v_and_b32 v231, s66, v43
    v_mul_f32 v106, v106, v107
    v_mul_f32 v231, v231, v29
    v_mfma_f32_32x32x16_bf16 v[160:175], v[204:207], a[100:103], v[160:175]
    v_fmac_f32 v231, v106, v28
    v_lshlrev_b32 v104, 16, v212
    v_lshlrev_b32 v105, 16, v36
    v_lshlrev_b32 v232, 16, v44
    s_waitcnt lgkmcnt(10)
    v_mfma_f32_32x32x16_bf16 v[112:127], v[176:179], a[104:107], v[112:127]
    v_mul_f32 v104, v104, v105
    v_mul_f32 v232, v232, v29
    s_waitcnt vmcnt(8)
    ds_read_b64_tr_b16 v[200:201], v3 offset:4096
    s_add_u32 s92, s91, 172032
    buffer_load_dwordx4 v[48:51], v10, s[40:43], s92 offen offset:0 sc1
    buffer_load_dwordx4 v[52:55], v11, s[40:43], s92 offen offset:0 sc1
    ds_read_b64_tr_b16 v[202:203], v3 offset:4608
    s_waitcnt lgkmcnt(10)
    v_mfma_f32_32x32x16_bf16 v[128:143], v[180:183], a[104:107], v[128:143]
    v_fmac_f32 v232, v104, v28
    v_and_b32 v106, s66, v212
    v_and_b32 v107, s66, v36
    ds_read_b64_tr_b16 v[204:205], v4 offset:4096
    ds_read_b64_tr_b16 v[206:207], v4 offset:4608
    v_mfma_f32_32x32x16_bf16 v[144:159], v[176:179], a[108:111], v[144:159]
    v_and_b32 v233, s66, v44
    v_mul_f32 v106, v106, v107
    v_mul_f32 v233, v233, v29
    v_fmac_f32 v233, v106, v28
    v_lshlrev_b32 v104, 16, v213
    v_mfma_f32_32x32x16_bf16 v[160:175], v[180:183], a[108:111], v[160:175]
    v_lshlrev_b32 v105, 16, v37
    v_lshlrev_b32 v234, 16, v45
    v_mul_f32 v104, v104, v105
    v_mul_f32 v234, v234, v29
    s_waitcnt vmcnt(8)
    buffer_load_dwordx4 v[56:59], v10, s[40:43], s92 offen offset:2048 sc1
    buffer_load_dwordx4 v[60:63], v11, s[40:43], s92 offen offset:2048 sc1
    s_waitcnt vmcnt(8)
    s_add_u32 s92, s91, 176128
    buffer_load_dwordx4 v[64:67], v10, s[40:43], s92 offen offset:0 sc1
    buffer_load_dwordx4 v[68:71], v11, s[40:43], s92 offen offset:0 sc1
    s_waitcnt vmcnt(8)
    buffer_load_dwordx4 v[72:75], v10, s[40:43], s92 offen offset:2048 sc1
    buffer_load_dwordx4 v[76:79], v11, s[40:43], s92 offen offset:2048 sc1
    s_waitcnt vmcnt(8)
    s_add_u32 s92, s91, 180224
    buffer_load_dwordx4 v[80:83], v10, s[40:43], s92 offen offset:0 sc1
    buffer_load_dwordx4 v[84:87], v11, s[40:43], s92 offen offset:0 sc1
    s_waitcnt vmcnt(9) lgkmcnt(10)
    v_mfma_f32_32x32x16_bf16 v[112:127], v[184:187], v[48:51], v[112:127]
    v_fmac_f32 v234, v104, v28
    v_and_b32 v106, s66, v213
    ds_read_b64_tr_b16 v[176:177], v3 offset:6144
    ds_read_b64_tr_b16 v[178:179], v3 offset:6656
    s_waitcnt lgkmcnt(10)
    v_mfma_f32_32x32x16_bf16 v[128:143], v[188:191], v[48:51], v[128:143]
    v_xor_b32 v23, 32768, v15
    v_and_b32 v107, s66, v37
    v_and_b32 v235, s66, v45
    ds_read_b64_tr_b16 v[180:181], v4 offset:6144
    ds_read_b64_tr_b16 v[182:183], v4 offset:6656
    s_waitcnt vmcnt(8)
    v_mfma_f32_32x32x16_bf16 v[144:159], v[184:187], v[52:55], v[144:159]
    buffer_load_dwordx4 v[88:91], v10, s[40:43], s92 offen offset:2048 sc1
    v_mul_f32 v106, v106, v107
    buffer_load_dwordx4 v[92:95], v11, s[40:43], s92 offen offset:2048 sc1
    v_mul_f32 v235, v235, v29
    v_fmac_f32 v235, v106, v28
    v_lshlrev_b32 v104, 16, v214
    v_lshlrev_b32 v105, 16, v38
    v_mfma_f32_32x32x16_bf16 v[160:175], v[188:191], v[52:55], v[160:175]
    v_lshlrev_b32 v236, 16, v46
    v_mul_f32 v104, v104, v105
    v_mul_f32 v236, v236, v29
    v_fmac_f32 v236, v104, v28
    s_waitcnt vmcnt(9) lgkmcnt(10)
    v_mfma_f32_32x32x16_bf16 v[112:127], v[192:195], v[56:59], v[112:127]
    v_and_b32 v106, s66, v214
    v_and_b32 v107, s66, v38
    ds_read_b64_tr_b16 v[184:185], v3 offset:8192
    ds_read_b64_tr_b16 v[186:187], v3 offset:8704
    s_waitcnt lgkmcnt(10)
    v_mfma_f32_32x32x16_bf16 v[128:143], v[196:199], v[56:59], v[128:143]
    v_and_b32 v237, s66, v46
    v_mul_f32 v106, v106, v107
    v_mul_f32 v237, v237, v29
    ds_read_b64_tr_b16 v[188:189], v4 offset:8192
    ds_read_b64_tr_b16 v[190:191], v4 offset:8704
    s_waitcnt vmcnt(8)
    v_mfma_f32_32x32x16_bf16 v[144:159], v[192:195], v[60:63], v[144:159]
    s_add_u32 s92, s91, 184320
    buffer_load_dwordx4 v[96:99], v10, s[40:43], s92 offen offset:0 sc1
    v_xor_b32 v24, 49152, v15
    buffer_load_dwordx4 v[100:103], v11, s[40:43], s92 offen offset:0 sc1
    v_fmac_f32 v237, v106, v28
    v_lshlrev_b32 v104, 16, v215
    v_lshlrev_b32 v105, 16, v39
    v_lshlrev_b32 v238, 16, v47
    v_mfma_f32_32x32x16_bf16 v[160:175], v[196:199], v[60:63], v[160:175]
    v_mul_f32 v104, v104, v105
    v_mul_f32 v238, v238, v29
    v_fmac_f32 v238, v104, v28
    v_and_b32 v106, s66, v215
    s_waitcnt vmcnt(9) lgkmcnt(10)
    v_mfma_f32_32x32x16_bf16 v[112:127], v[200:203], v[64:67], v[112:127]
    v_and_b32 v107, s66, v39
    v_and_b32 v239, s66, v47
    ds_read_b64_tr_b16 v[192:193], v3 offset:10240
    ds_read_b64_tr_b16 v[194:195], v3 offset:10752
    s_waitcnt lgkmcnt(10)
    v_mfma_f32_32x32x16_bf16 v[128:143], v[204:207], v[64:67], v[128:143]
    v_mul_f32 v106, v106, v107
    v_mul_f32 v239, v239, v29
    v_fmac_f32 v239, v106, v28
    ds_read_b64_tr_b16 v[196:197], v4 offset:10240
    ds_read_b64_tr_b16 v[198:199], v4 offset:10752
    s_waitcnt vmcnt(8)
    v_mfma_f32_32x32x16_bf16 v[144:159], v[200:203], v[68:71], v[144:159]
    v_mfma_f32_32x32x16_bf16 v[160:175], v[204:207], v[68:71], v[160:175]
    v_xor_b32 v25, 16384, v15
    s_waitcnt vmcnt(7) lgkmcnt(8)
    v_mfma_f32_32x32x16_bf16 v[128:143], v[180:183], v[72:75], v[128:143]
    ds_read_b64_tr_b16 v[200:201], v3 offset:12288
    ds_read_b64_tr_b16 v[202:203], v3 offset:12800
    ds_read_b64_tr_b16 v[204:205], v4 offset:12288
    ds_read_b64_tr_b16 v[206:207], v4 offset:12800
    s_waitcnt vmcnt(5) lgkmcnt(8)
    v_mfma_f32_32x32x16_bf16 v[128:143], v[188:191], v[80:83], v[128:143]
    s_waitcnt vmcnt(3) lgkmcnt(4)
    v_mfma_f32_32x32x16_bf16 v[128:143], v[196:199], v[88:91], v[128:143]
    s_waitcnt vmcnt(1) lgkmcnt(0)
    v_mfma_f32_32x32x16_bf16 v[128:143], v[204:207], v[96:99], v[128:143]
    v_mfma_f32_32x32x16_bf16 v[144:159], v[176:179], v[76:79], v[144:159]
    v_mfma_f32_32x32x16_bf16 v[144:159], v[184:187], v[84:87], v[144:159]
    s_nop 9
    ds_write_b128 v15, v[128:131] offset:0
    v_mfma_f32_32x32x16_bf16 v[144:159], v[192:195], v[92:95], v[144:159]
    ds_write_b128 v15, v[132:135] offset:1024
    s_waitcnt vmcnt(0)
    v_mfma_f32_32x32x16_bf16 v[144:159], v[200:203], v[100:103], v[144:159]
    ds_write_b128 v15, v[136:139] offset:2048
    v_mfma_f32_32x32x16_bf16 v[160:175], v[180:183], v[76:79], v[160:175]
    ds_write_b128 v15, v[140:143] offset:3072
    v_mfma_f32_32x32x16_bf16 v[160:175], v[188:191], v[84:87], v[160:175]
    s_nop 7
    ds_write_b128 v15, v[144:147] offset:4096
    v_mfma_f32_32x32x16_bf16 v[160:175], v[196:199], v[92:95], v[160:175]
    ds_write_b128 v15, v[148:151] offset:5120
    v_mfma_f32_32x32x16_bf16 v[160:175], v[204:207], v[100:103], v[160:175]
    ds_write_b128 v15, v[152:155] offset:6144
    v_mfma_f32_32x32x16_bf16 v[112:127], v[176:179], v[72:75], v[112:127]
    ds_write_b128 v15, v[156:159] offset:7168
    v_mfma_f32_32x32x16_bf16 v[112:127], v[184:187], v[80:83], v[112:127]
    s_nop 7
    ds_write_b128 v15, v[160:163] offset:8192
    ds_write_b128 v15, v[164:167] offset:9216
    v_mfma_f32_32x32x16_bf16 v[112:127], v[192:195], v[88:91], v[112:127]
    ds_write_b128 v15, v[168:171] offset:10240
    v_mfma_f32_32x32x16_bf16 v[112:127], v[200:203], v[96:99], v[112:127]
    ds_write_b128 v15, v[172:175] offset:11264
    s_waitcnt lgkmcnt(0)
    s_barrier
    ds_read_b128 v[128:131], v23 offset:0
    ds_read_b128 v[132:135], v23 offset:1024
    ds_read_b128 v[136:139], v23 offset:2048
    ds_read_b128 v[140:143], v23 offset:3072
    ds_read_b128 v[144:147], v24 offset:4096
    ds_read_b128 v[148:151], v24 offset:5120
    ds_read_b128 v[152:155], v24 offset:6144
    ds_read_b128 v[156:159], v24 offset:7168
    ds_read_b128 v[160:163], v25 offset:8192
    ds_read_b128 v[164:167], v25 offset:9216
    ds_read_b128 v[168:171], v25 offset:10240
    ds_read_b128 v[172:175], v25 offset:11264
    s_waitcnt lgkmcnt(11)
    v_pk_add_f32 v[112:113], v[112:113], v[128:129]
    v_pk_add_f32 v[114:115], v[114:115], v[130:131]
    s_waitcnt lgkmcnt(10)
    v_pk_add_f32 v[116:117], v[116:117], v[132:133]
    v_pk_add_f32 v[118:119], v[118:119], v[134:135]
    s_waitcnt lgkmcnt(7)
    v_pk_add_f32 v[112:113], v[112:113], v[144:145]
    v_pk_add_f32 v[114:115], v[114:115], v[146:147]
    s_waitcnt lgkmcnt(6)
    v_pk_add_f32 v[116:117], v[116:117], v[148:149]
    v_pk_add_f32 v[118:119], v[118:119], v[150:151]
    s_waitcnt lgkmcnt(3)
    v_pk_add_f32 v[112:113], v[112:113], v[160:161]
    v_pk_add_f32 v[114:115], v[114:115], v[162:163]
    s_waitcnt lgkmcnt(2)
    v_pk_add_f32 v[116:117], v[116:117], v[164:165]
    v_pk_add_f32 v[118:119], v[118:119], v[166:167]
    v_pk_fma_f32 v[112:113], v[112:113], v[28:29], v[224:225] op_sel:[0,1,0] op_sel_hi:[1,1,1]
    v_pk_fma_f32 v[114:115], v[114:115], v[28:29], v[226:227] op_sel:[0,1,0] op_sel_hi:[1,1,1]
    v_pk_fma_f32 v[116:117], v[116:117], v[28:29], v[228:229] op_sel:[0,1,0] op_sel_hi:[1,1,1]
    v_pk_fma_f32 v[118:119], v[118:119], v[28:29], v[230:231] op_sel:[0,1,0] op_sel_hi:[1,1,1]
    v_cvt_pk_bf16_f32 v208, v112, v113
    v_cvt_pk_bf16_f32 v209, v114, v115
    v_cvt_pk_bf16_f32 v210, v116, v117
    v_cvt_pk_bf16_f32 v211, v118, v119
    buffer_store_dwordx4 v[208:211], v27, s[36:39], 0 offen offset:0
    v_pk_add_f32 v[120:121], v[120:121], v[136:137]
    v_pk_add_f32 v[122:123], v[122:123], v[138:139]
    v_pk_add_f32 v[124:125], v[124:125], v[140:141]
    v_pk_add_f32 v[126:127], v[126:127], v[142:143]
    v_pk_add_f32 v[120:121], v[120:121], v[152:153]
    v_pk_add_f32 v[122:123], v[122:123], v[154:155]
    v_pk_add_f32 v[124:125], v[124:125], v[156:157]
    v_pk_add_f32 v[126:127], v[126:127], v[158:159]
    s_waitcnt lgkmcnt(1)
    v_pk_add_f32 v[120:121], v[120:121], v[168:169]
    v_pk_add_f32 v[122:123], v[122:123], v[170:171]
    s_waitcnt lgkmcnt(0)
    v_pk_add_f32 v[124:125], v[124:125], v[172:173]
    v_pk_add_f32 v[126:127], v[126:127], v[174:175]
    v_pk_fma_f32 v[120:121], v[120:121], v[28:29], v[232:233] op_sel:[0,1,0] op_sel_hi:[1,1,1]
    v_pk_fma_f32 v[122:123], v[122:123], v[28:29], v[234:235] op_sel:[0,1,0] op_sel_hi:[1,1,1]
    v_pk_fma_f32 v[124:125], v[124:125], v[28:29], v[236:237] op_sel:[0,1,0] op_sel_hi:[1,1,1]
    v_pk_fma_f32 v[126:127], v[126:127], v[28:29], v[238:239] op_sel:[0,1,0] op_sel_hi:[1,1,1]
    v_cvt_pk_bf16_f32 v212, v120, v121
    v_cvt_pk_bf16_f32 v213, v122, v123
    v_cvt_pk_bf16_f32 v214, v124, v125
    v_cvt_pk_bf16_f32 v215, v126, v127
    buffer_store_dwordx4 v[212:215], v27, s[36:39], 0 offen offset:32
    s_or_b32 s67, s2, s54
    s_cmp_eq_u32 s67, 0
    s_cselect_b32 s67, 0, 18874368
    s_add_u32 s67, s67, 262144
    s_add_u32 s68, s64, 8
    v_mov_b32 v18, s68
    s_mov_b64 exec, 1
    buffer_store_dword v18, v19, s[40:43], s67 offen sc1
    s_mov_b64 exec, -1
L_end:
    s_endpgm
L_code_end:
.section .rodata,"a"
.p2align 6
.amdhsa_kernel gated_mix__ssm_conv_h3__mixer_s_mlp__prompt_kernel
  .amdhsa_next_free_vgpr 512
  .amdhsa_next_free_sgpr 102
  .amdhsa_accum_offset 256
  .amdhsa_group_segment_fixed_size 0
  .amdhsa_kernarg_size 120
  .amdhsa_user_sgpr_count 2
  .amdhsa_user_sgpr_kernarg_segment_ptr 1
  .amdhsa_system_sgpr_workgroup_id_x 1
.end_amdhsa_kernel
```
